```python
import torch

def _softmax(x, axis=-1):
    return torch.softmax(x, dim=axis)
def _gelu(x):
    return torch.nn.functional.gelu(x, approximate="tanh")
def _silu(x):
    return torch.nn.functional.silu(x)
def _sigmoid(x):
    return torch.sigmoid(x)
def _layernorm(x, axis=-1, eps=1e-5):
    m = x.mean(dim=axis, keepdim=True)
    v = x.var(dim=axis, keepdim=True, unbiased=False)
    return (x - m) / torch.sqrt(v + eps)
def _scatter_add(tgt, idx, src, axis=0):
    return tgt.clone().index_add_(axis, idx, src)
def _segment_sum(src, seg, n):
    out = torch.zeros((n,) + src.shape[1:], dtype=src.dtype)
    return out.index_add_(0, seg, src)
def _pad(x, pw):
    flat = tuple(v for pair in reversed(pw) for v in pair)
    return torch.nn.functional.pad(x, flat)

kernel_name = 'standalone__mha_softmax__near_ridge'

def setup_inputs():

    _w = (lambda a: (lambda t: t.to(torch.bfloat16) if t.is_floating_point() else t)(torch.as_tensor(a)))
    B, H, Sq, Sk, D = 16, 32, 384, 512, 192
    return {
        "q": _w((lambda *s: torch.randn(*s, dtype=torch.bfloat16) * 0.8)(B, H, Sq, D)),
        "k": _w((lambda *s: torch.randn(*s, dtype=torch.bfloat16) * 0.8)(B, H, Sk, D)),
        "v": _w((lambda *s: torch.randn(*s, dtype=torch.bfloat16) * 0.05)(B, H, Sk, D)),
    }

def reference(q, k, v):
    scale = q.shape[-1] ** -0.5
    scores = torch.einsum("bhqd,bhkd->bhqk", q, k) * scale
    p = _softmax(scores, axis=-1)
    return torch.einsum("bhqk,bhkd->bhqd", p, v)
```

```asm
; @launch grid=(256,1,1) block=(256,1,1) lds=163840
.amdgcn_target "amdgcn-amd-amdhsa--gfx950"
.text
.globl standalone__mha_softmax__near_ridge_kernel
.p2align 8
.type standalone__mha_softmax__near_ridge_kernel,@function
standalone__mha_softmax__near_ridge_kernel:
    s_cmp_ge_u32 s2, 256
    s_cbranch_scc1 L_end
    s_load_dwordx4 s[44:47], s[0:1], 0
    s_load_dwordx4 s[48:51], s[0:1], 16
    v_lshrrev_b32 v1, 6, v0
    v_and_b32 v0, 63, v0
    v_readfirstlane_b32 s3, v1
    v_lshrrev_b32 v2, 3, v0
    v_and_b32 v3, 6, v2
    v_and_b32 v4, 7, v0
    v_xor_b32 v3, v3, v4
    v_lshlrev_b32 v3, 4, v3
    v_mul_u32_u24 v2, 384, v2
    v_add_u32 v254, v2, v3
    v_lshrrev_b32 v2, 2, v0
    v_and_b32 v3, 3, v0
    v_cmp_eq_u32 vcc, v2, v3
    v_mov_b32 v4, 0x3f803f80
    s_nop 0
    v_cndmask_b32 v4, 0, v4, vcc
    v_accvgpr_write_b32 a176, v4
    v_accvgpr_write_b32 a177, v4
    s_mul_i32 s42, s2, 294912
    s_mul_i32 s43, s2, 393216
    s_mul_i32 s35, s3, 36864
    s_mul_i32 s25, s3, 3072
    s_mul_i32 s36, s3, 22528
    s_add_u32 s36, s36, 73728
    s_add_u32 s26, s25, 0
    s_lshr_b32 s40, s3, 1
    s_mul_i32 s40, s40, 36864
    s_and_b32 s41, s3, 1
    s_mul_i32 s41, s41, 6144
    s_add_u32 s40, s40, s41
    s_add_u32 s40, s40, 24576
    s_add_u32 s41, s40, 6144
    s_waitcnt lgkmcnt(0)
    s_add_u32 s8, s46, s43
    s_addc_u32 s9, s47, 0
    s_mov_b32 s10, 393216
    s_mov_b32 s11, 0x20000
    s_add_u32 s4, s44, s42
    s_addc_u32 s5, s45, 0
    s_mov_b32 s6, 294912
    s_mov_b32 s7, 0x20000
    s_mov_b32 m0, s26
    s_nop 0
    buffer_load_dwordx4 v254, s[8:11], s25 offen offset:0 nt lds
    s_add_u32 m0, s26, 896
    s_nop 0
    buffer_load_dwordx4 v254, s[8:11], s25 offen offset:128 nt lds
    s_add_u32 m0, s26, 1792
    s_nop 0
    buffer_load_dwordx4 v254, s[8:11], s25 offen offset:256 nt lds
    s_add_u32 m0, s40, 0
    s_add_u32 s44, s35, 0
    buffer_load_dwordx4 v254, s[4:7], s44 offen offset:0 nt lds
    s_add_u32 m0, s40, 896
    s_add_u32 s44, s35, 0
    buffer_load_dwordx4 v254, s[4:7], s44 offen offset:128 nt lds
    s_add_u32 m0, s40, 1792
    s_add_u32 s44, s35, 0
    buffer_load_dwordx4 v254, s[4:7], s44 offen offset:256 nt lds
    s_add_u32 m0, s40, 3072
    s_add_u32 s44, s35, 3072
    buffer_load_dwordx4 v254, s[4:7], s44 offen offset:0 nt lds
    s_add_u32 m0, s40, 3968
    s_add_u32 s44, s35, 3072
    buffer_load_dwordx4 v254, s[4:7], s44 offen offset:128 nt lds
    s_add_u32 m0, s40, 4864
    s_add_u32 s44, s35, 3072
    buffer_load_dwordx4 v254, s[4:7], s44 offen offset:256 nt lds
    s_add_u32 s12, s48, s43
    s_addc_u32 s13, s49, 0
    s_mov_b32 s14, 393216
    s_mov_b32 s15, 0x20000
    s_add_u32 s16, s50, s42
    s_addc_u32 s17, s51, 0
    s_mov_b32 s18, 294912
    s_mov_b32 s19, 0x20000
    s_add_u32 s45, s35, 147456
    s_add_u32 s20, s4, s45
    s_addc_u32 s21, s5, 0
    s_mov_b32 s22, 24576
    s_mov_b32 s23, 0x20000
    s_add_u32 s37, s36, 18432
    s_mov_b32 s31, s37
    s_mov_b32 s32, 1048576
    s_mov_b32 s27, 12288
    s_mov_b32 s28, 0
    s_mov_b32 s38, 5888
    s_mov_b32 s39, 4096
    s_mov_b32 s48, 2816
    s_mov_b32 s49, 0xffff0000
    s_mov_b32 s47, -24576
    s_add_u32 s46, s26, 24576
    s_mov_b32 s24, 0x3dd53b95
    s_mov_b32 s50, s24
    s_mov_b32 s51, s24
    s_mov_b32 s34, 0
    v_lshrrev_b32 v2, 4, v0
    v_and_b32 v3, 6, v0
    v_xor_b32 v2, v2, v3
    v_lshlrev_b32 v2, 4, v2
    v_and_b32 v3, 7, v0
    v_lshl_add_u32 v2, v3, 7, v2
    v_bfe_u32 v3, v0, 3, 1
    v_mul_u32_u24 v3, 3072, v3
    v_add_u32 v252, v2, v3
    v_bfe_u32 v2, v0, 2, 3
    v_and_b32 v3, 6, v2
    v_lshlrev_b32 v3, 4, v3
    v_lshl_add_u32 v2, v2, 7, v3
    v_and_b32 v3, 3, v0
    v_lshl_add_u32 v2, v3, 3, v2
    v_lshrrev_b32 v3, 5, v0
    v_mul_u32_u24 v3, 3072, v3
    v_add_u32 v253, v2, v3
    v_add_u32 v253, 36864, v253
    v_add_u32 v0, s36, v252
    v_xor_b32 v1, 64, v0
    v_add_u32 v2, s40, v252
    v_xor_b32 v3, 64, v2
    s_add_u32 m0, s36, 0
    s_add_u32 s44, s35, 6144
    buffer_load_dwordx4 v254, s[4:7], s44 offen offset:0 nt lds
    s_add_u32 m0, s36, 896
    s_add_u32 s44, s35, 6144
    buffer_load_dwordx4 v254, s[4:7], s44 offen offset:128 nt lds
    s_add_u32 m0, s36, 1792
    s_add_u32 s44, s35, 6144
    buffer_load_dwordx4 v254, s[4:7], s44 offen offset:256 nt lds
    s_add_u32 m0, s36, 3072
    s_add_u32 s44, s35, 9216
    buffer_load_dwordx4 v254, s[4:7], s44 offen offset:0 nt lds
    s_add_u32 m0, s36, 3968
    s_add_u32 s44, s35, 9216
    buffer_load_dwordx4 v254, s[4:7], s44 offen offset:128 nt lds
    s_add_u32 m0, s36, 4864
    s_add_u32 s44, s35, 9216
    buffer_load_dwordx4 v254, s[4:7], s44 offen offset:256 nt lds
    s_add_u32 m0, s36, 6144
    s_add_u32 s44, s35, 12288
    buffer_load_dwordx4 v254, s[4:7], s44 offen offset:0 nt lds
    s_add_u32 m0, s36, 7040
    s_add_u32 s44, s35, 12288
    buffer_load_dwordx4 v254, s[4:7], s44 offen offset:128 nt lds
    s_add_u32 m0, s36, 7936
    s_add_u32 s44, s35, 12288
    buffer_load_dwordx4 v254, s[4:7], s44 offen offset:256 nt lds
    s_add_u32 m0, s36, 9216
    s_add_u32 s44, s35, 15360
    buffer_load_dwordx4 v254, s[4:7], s44 offen offset:0 nt lds
    s_add_u32 m0, s36, 10112
    s_add_u32 s44, s35, 15360
    buffer_load_dwordx4 v254, s[4:7], s44 offen offset:128 nt lds
    s_add_u32 m0, s36, 11008
    s_add_u32 s44, s35, 15360
    buffer_load_dwordx4 v254, s[4:7], s44 offen offset:256 nt lds
    s_waitcnt vmcnt(12)
    s_barrier
    ds_read_b128 v[8:11], v2 offset:0
    ds_read_b128 v[12:15], v3 offset:0
    ds_read_b128 v[16:19], v2 offset:1024
    ds_read_b128 v[20:23], v3 offset:1024
    ds_read_b128 v[24:27], v2 offset:2048
    ds_read_b128 v[28:31], v3 offset:2048
    s_add_u32 m0, s36, 12288
    s_add_u32 s44, s35, 18432
    buffer_load_dwordx4 v254, s[4:7], s44 offen offset:0 nt lds
    s_waitcnt lgkmcnt(5)
    v_lshlrev_b32 v40, 16, v8
    v_and_b32 v41, s49, v8
    v_lshlrev_b32 v42, 16, v9
    v_and_b32 v43, s49, v9
    v_lshlrev_b32 v44, 16, v10
    v_and_b32 v45, s49, v10
    v_lshlrev_b32 v46, 16, v11
    v_and_b32 v47, s49, v11
    v_pk_mul_f32 v[40:41], v[40:41], s[50:51]
    v_pk_mul_f32 v[42:43], v[42:43], s[50:51]
    v_pk_mul_f32 v[44:45], v[44:45], s[50:51]
    v_pk_mul_f32 v[46:47], v[46:47], s[50:51]
    v_cvt_pk_bf16_f32 v40, v40, v41
    v_cvt_pk_bf16_f32 v41, v42, v43
    v_cvt_pk_bf16_f32 v42, v44, v45
    v_cvt_pk_bf16_f32 v43, v46, v47
    v_accvgpr_write_b32 a0, v40
    v_accvgpr_write_b32 a1, v41
    v_accvgpr_write_b32 a2, v42
    v_accvgpr_write_b32 a3, v43
    s_add_u32 m0, s36, 13184
    s_add_u32 s44, s35, 18432
    buffer_load_dwordx4 v254, s[4:7], s44 offen offset:128 nt lds
    s_waitcnt lgkmcnt(4)
    v_lshlrev_b32 v48, 16, v12
    v_and_b32 v49, s49, v12
    v_lshlrev_b32 v50, 16, v13
    v_and_b32 v51, s49, v13
    v_lshlrev_b32 v52, 16, v14
    v_and_b32 v53, s49, v14
    v_lshlrev_b32 v54, 16, v15
    v_and_b32 v55, s49, v15
    v_pk_mul_f32 v[48:49], v[48:49], s[50:51]
    v_pk_mul_f32 v[50:51], v[50:51], s[50:51]
    v_pk_mul_f32 v[52:53], v[52:53], s[50:51]
    v_pk_mul_f32 v[54:55], v[54:55], s[50:51]
    v_cvt_pk_bf16_f32 v48, v48, v49
    v_cvt_pk_bf16_f32 v49, v50, v51
    v_cvt_pk_bf16_f32 v50, v52, v53
    v_cvt_pk_bf16_f32 v51, v54, v55
    v_accvgpr_write_b32 a4, v48
    v_accvgpr_write_b32 a5, v49
    v_accvgpr_write_b32 a6, v50
    v_accvgpr_write_b32 a7, v51
    s_add_u32 m0, s36, 14080
    s_add_u32 s44, s35, 18432
    buffer_load_dwordx4 v254, s[4:7], s44 offen offset:256 nt lds
    s_waitcnt lgkmcnt(3)
    v_lshlrev_b32 v40, 16, v16
    v_and_b32 v41, s49, v16
    v_lshlrev_b32 v42, 16, v17
    v_and_b32 v43, s49, v17
    v_lshlrev_b32 v44, 16, v18
    v_and_b32 v45, s49, v18
    v_lshlrev_b32 v46, 16, v19
    v_and_b32 v47, s49, v19
    v_pk_mul_f32 v[40:41], v[40:41], s[50:51]
    v_pk_mul_f32 v[42:43], v[42:43], s[50:51]
    v_pk_mul_f32 v[44:45], v[44:45], s[50:51]
    v_pk_mul_f32 v[46:47], v[46:47], s[50:51]
    v_cvt_pk_bf16_f32 v40, v40, v41
    v_cvt_pk_bf16_f32 v41, v42, v43
    v_cvt_pk_bf16_f32 v42, v44, v45
    v_cvt_pk_bf16_f32 v43, v46, v47
    v_accvgpr_write_b32 a8, v40
    v_accvgpr_write_b32 a9, v41
    v_accvgpr_write_b32 a10, v42
    v_accvgpr_write_b32 a11, v43
    s_add_u32 m0, s36, 15360
    s_add_u32 s44, s35, 21504
    buffer_load_dwordx4 v254, s[4:7], s44 offen offset:0 nt lds
    s_waitcnt lgkmcnt(2)
    v_lshlrev_b32 v48, 16, v20
    v_and_b32 v49, s49, v20
    v_lshlrev_b32 v50, 16, v21
    v_and_b32 v51, s49, v21
    v_lshlrev_b32 v52, 16, v22
    v_and_b32 v53, s49, v22
    v_lshlrev_b32 v54, 16, v23
    v_and_b32 v55, s49, v23
    v_pk_mul_f32 v[48:49], v[48:49], s[50:51]
    v_pk_mul_f32 v[50:51], v[50:51], s[50:51]
    v_pk_mul_f32 v[52:53], v[52:53], s[50:51]
    v_pk_mul_f32 v[54:55], v[54:55], s[50:51]
    v_cvt_pk_bf16_f32 v48, v48, v49
    v_cvt_pk_bf16_f32 v49, v50, v51
    v_cvt_pk_bf16_f32 v50, v52, v53
    v_cvt_pk_bf16_f32 v51, v54, v55
    v_accvgpr_write_b32 a12, v48
    v_accvgpr_write_b32 a13, v49
    v_accvgpr_write_b32 a14, v50
    v_accvgpr_write_b32 a15, v51
    s_add_u32 m0, s36, 16256
    s_add_u32 s44, s35, 21504
    buffer_load_dwordx4 v254, s[4:7], s44 offen offset:128 nt lds
    s_waitcnt lgkmcnt(1)
    v_lshlrev_b32 v40, 16, v24
    v_and_b32 v41, s49, v24
    v_lshlrev_b32 v42, 16, v25
    v_and_b32 v43, s49, v25
    v_lshlrev_b32 v44, 16, v26
    v_and_b32 v45, s49, v26
    v_lshlrev_b32 v46, 16, v27
    v_and_b32 v47, s49, v27
    v_pk_mul_f32 v[40:41], v[40:41], s[50:51]
    v_pk_mul_f32 v[42:43], v[42:43], s[50:51]
    v_pk_mul_f32 v[44:45], v[44:45], s[50:51]
    v_pk_mul_f32 v[46:47], v[46:47], s[50:51]
    v_cvt_pk_bf16_f32 v40, v40, v41
    v_cvt_pk_bf16_f32 v41, v42, v43
    v_cvt_pk_bf16_f32 v42, v44, v45
    v_cvt_pk_bf16_f32 v43, v46, v47
    v_accvgpr_write_b32 a16, v40
    v_accvgpr_write_b32 a17, v41
    v_accvgpr_write_b32 a18, v42
    v_accvgpr_write_b32 a19, v43
    s_add_u32 m0, s36, 17152
    s_add_u32 s44, s35, 21504
    buffer_load_dwordx4 v254, s[4:7], s44 offen offset:256 nt lds
    s_waitcnt lgkmcnt(0)
    v_lshlrev_b32 v48, 16, v28
    v_and_b32 v49, s49, v28
    v_lshlrev_b32 v50, 16, v29
    v_and_b32 v51, s49, v29
    v_lshlrev_b32 v52, 16, v30
    v_and_b32 v53, s49, v30
    v_lshlrev_b32 v54, 16, v31
    v_and_b32 v55, s49, v31
    v_pk_mul_f32 v[48:49], v[48:49], s[50:51]
    v_pk_mul_f32 v[50:51], v[50:51], s[50:51]
    v_pk_mul_f32 v[52:53], v[52:53], s[50:51]
    v_pk_mul_f32 v[54:55], v[54:55], s[50:51]
    v_cvt_pk_bf16_f32 v48, v48, v49
    v_cvt_pk_bf16_f32 v49, v50, v51
    v_cvt_pk_bf16_f32 v50, v52, v53
    v_cvt_pk_bf16_f32 v51, v54, v55
    v_accvgpr_write_b32 a20, v48
    v_accvgpr_write_b32 a21, v49
    v_accvgpr_write_b32 a22, v50
    v_accvgpr_write_b32 a23, v51
    s_waitcnt vmcnt(12)
    ds_read_b128 v[8:11], v0 offset:0
    ds_read_b128 v[12:15], v1 offset:0
    ds_read_b128 v[16:19], v0 offset:1024
    ds_read_b128 v[20:23], v1 offset:1024
    ds_read_b128 v[24:27], v0 offset:2048
    ds_read_b128 v[28:31], v1 offset:2048
    s_add_u32 m0, s40, 0
    s_add_u32 s44, s35, 24576
    buffer_load_dwordx4 v254, s[4:7], s44 offen offset:0 nt lds
    s_waitcnt lgkmcnt(5)
    v_lshlrev_b32 v40, 16, v8
    v_and_b32 v41, s49, v8
    v_lshlrev_b32 v42, 16, v9
    v_and_b32 v43, s49, v9
    v_lshlrev_b32 v44, 16, v10
    v_and_b32 v45, s49, v10
    v_lshlrev_b32 v46, 16, v11
    v_and_b32 v47, s49, v11
    v_pk_mul_f32 v[40:41], v[40:41], s[50:51]
    v_pk_mul_f32 v[42:43], v[42:43], s[50:51]
    v_pk_mul_f32 v[44:45], v[44:45], s[50:51]
    v_pk_mul_f32 v[46:47], v[46:47], s[50:51]
    v_cvt_pk_bf16_f32 v40, v40, v41
    v_cvt_pk_bf16_f32 v41, v42, v43
    v_cvt_pk_bf16_f32 v42, v44, v45
    v_cvt_pk_bf16_f32 v43, v46, v47
    v_accvgpr_write_b32 a24, v40
    v_accvgpr_write_b32 a25, v41
    v_accvgpr_write_b32 a26, v42
    v_accvgpr_write_b32 a27, v43
    s_add_u32 m0, s40, 896
    s_add_u32 s44, s35, 24576
    buffer_load_dwordx4 v254, s[4:7], s44 offen offset:128 nt lds
    s_waitcnt lgkmcnt(4)
    v_lshlrev_b32 v48, 16, v12
    v_and_b32 v49, s49, v12
    v_lshlrev_b32 v50, 16, v13
    v_and_b32 v51, s49, v13
    v_lshlrev_b32 v52, 16, v14
    v_and_b32 v53, s49, v14
    v_lshlrev_b32 v54, 16, v15
    v_and_b32 v55, s49, v15
    v_pk_mul_f32 v[48:49], v[48:49], s[50:51]
    v_pk_mul_f32 v[50:51], v[50:51], s[50:51]
    v_pk_mul_f32 v[52:53], v[52:53], s[50:51]
    v_pk_mul_f32 v[54:55], v[54:55], s[50:51]
    v_cvt_pk_bf16_f32 v48, v48, v49
    v_cvt_pk_bf16_f32 v49, v50, v51
    v_cvt_pk_bf16_f32 v50, v52, v53
    v_cvt_pk_bf16_f32 v51, v54, v55
    v_accvgpr_write_b32 a28, v48
    v_accvgpr_write_b32 a29, v49
    v_accvgpr_write_b32 a30, v50
    v_accvgpr_write_b32 a31, v51
    s_add_u32 m0, s40, 1792
    s_add_u32 s44, s35, 24576
    buffer_load_dwordx4 v254, s[4:7], s44 offen offset:256 nt lds
    s_waitcnt lgkmcnt(3)
    v_lshlrev_b32 v40, 16, v16
    v_and_b32 v41, s49, v16
    v_lshlrev_b32 v42, 16, v17
    v_and_b32 v43, s49, v17
    v_lshlrev_b32 v44, 16, v18
    v_and_b32 v45, s49, v18
    v_lshlrev_b32 v46, 16, v19
    v_and_b32 v47, s49, v19
    v_pk_mul_f32 v[40:41], v[40:41], s[50:51]
    v_pk_mul_f32 v[42:43], v[42:43], s[50:51]
    v_pk_mul_f32 v[44:45], v[44:45], s[50:51]
    v_pk_mul_f32 v[46:47], v[46:47], s[50:51]
    v_cvt_pk_bf16_f32 v40, v40, v41
    v_cvt_pk_bf16_f32 v41, v42, v43
    v_cvt_pk_bf16_f32 v42, v44, v45
    v_cvt_pk_bf16_f32 v43, v46, v47
    v_accvgpr_write_b32 a32, v40
    v_accvgpr_write_b32 a33, v41
    v_accvgpr_write_b32 a34, v42
    v_accvgpr_write_b32 a35, v43
    s_add_u32 m0, s40, 3072
    s_add_u32 s44, s35, 27648
    buffer_load_dwordx4 v254, s[4:7], s44 offen offset:0 nt lds
    s_waitcnt lgkmcnt(2)
    v_lshlrev_b32 v48, 16, v20
    v_and_b32 v49, s49, v20
    v_lshlrev_b32 v50, 16, v21
    v_and_b32 v51, s49, v21
    v_lshlrev_b32 v52, 16, v22
    v_and_b32 v53, s49, v22
    v_lshlrev_b32 v54, 16, v23
    v_and_b32 v55, s49, v23
    v_pk_mul_f32 v[48:49], v[48:49], s[50:51]
    v_pk_mul_f32 v[50:51], v[50:51], s[50:51]
    v_pk_mul_f32 v[52:53], v[52:53], s[50:51]
    v_pk_mul_f32 v[54:55], v[54:55], s[50:51]
    v_cvt_pk_bf16_f32 v48, v48, v49
    v_cvt_pk_bf16_f32 v49, v50, v51
    v_cvt_pk_bf16_f32 v50, v52, v53
    v_cvt_pk_bf16_f32 v51, v54, v55
    v_accvgpr_write_b32 a36, v48
    v_accvgpr_write_b32 a37, v49
    v_accvgpr_write_b32 a38, v50
    v_accvgpr_write_b32 a39, v51
    s_add_u32 m0, s40, 3968
    s_add_u32 s44, s35, 27648
    buffer_load_dwordx4 v254, s[4:7], s44 offen offset:128 nt lds
    s_waitcnt lgkmcnt(1)
    v_lshlrev_b32 v40, 16, v24
    v_and_b32 v41, s49, v24
    v_lshlrev_b32 v42, 16, v25
    v_and_b32 v43, s49, v25
    v_lshlrev_b32 v44, 16, v26
    v_and_b32 v45, s49, v26
    v_lshlrev_b32 v46, 16, v27
    v_and_b32 v47, s49, v27
    v_pk_mul_f32 v[40:41], v[40:41], s[50:51]
    v_pk_mul_f32 v[42:43], v[42:43], s[50:51]
    v_pk_mul_f32 v[44:45], v[44:45], s[50:51]
    v_pk_mul_f32 v[46:47], v[46:47], s[50:51]
    v_cvt_pk_bf16_f32 v40, v40, v41
    v_cvt_pk_bf16_f32 v41, v42, v43
    v_cvt_pk_bf16_f32 v42, v44, v45
    v_cvt_pk_bf16_f32 v43, v46, v47
    v_accvgpr_write_b32 a40, v40
    v_accvgpr_write_b32 a41, v41
    v_accvgpr_write_b32 a42, v42
    v_accvgpr_write_b32 a43, v43
    s_add_u32 m0, s40, 4864
    s_add_u32 s44, s35, 27648
    buffer_load_dwordx4 v254, s[4:7], s44 offen offset:256 nt lds
    s_waitcnt lgkmcnt(0)
    v_lshlrev_b32 v48, 16, v28
    v_and_b32 v49, s49, v28
    v_lshlrev_b32 v50, 16, v29
    v_and_b32 v51, s49, v29
    v_lshlrev_b32 v52, 16, v30
    v_and_b32 v53, s49, v30
    v_lshlrev_b32 v54, 16, v31
    v_and_b32 v55, s49, v31
    v_pk_mul_f32 v[48:49], v[48:49], s[50:51]
    v_pk_mul_f32 v[50:51], v[50:51], s[50:51]
    v_pk_mul_f32 v[52:53], v[52:53], s[50:51]
    v_pk_mul_f32 v[54:55], v[54:55], s[50:51]
    v_cvt_pk_bf16_f32 v48, v48, v49
    v_cvt_pk_bf16_f32 v49, v50, v51
    v_cvt_pk_bf16_f32 v50, v52, v53
    v_cvt_pk_bf16_f32 v51, v54, v55
    v_accvgpr_write_b32 a44, v48
    v_accvgpr_write_b32 a45, v49
    v_accvgpr_write_b32 a46, v50
    v_accvgpr_write_b32 a47, v51
    s_waitcnt vmcnt(12)
    ds_read_b128 v[8:11], v0 offset:6144
    ds_read_b128 v[12:15], v1 offset:6144
    ds_read_b128 v[16:19], v0 offset:7168
    ds_read_b128 v[20:23], v1 offset:7168
    ds_read_b128 v[24:27], v0 offset:8192
    ds_read_b128 v[28:31], v1 offset:8192
    s_add_u32 m0, s36, 0
    s_add_u32 s44, s35, 30720
    buffer_load_dwordx4 v254, s[4:7], s44 offen offset:0 nt lds
    s_waitcnt lgkmcnt(5)
    v_lshlrev_b32 v40, 16, v8
    v_and_b32 v41, s49, v8
    v_lshlrev_b32 v42, 16, v9
    v_and_b32 v43, s49, v9
    v_lshlrev_b32 v44, 16, v10
    v_and_b32 v45, s49, v10
    v_lshlrev_b32 v46, 16, v11
    v_and_b32 v47, s49, v11
    v_pk_mul_f32 v[40:41], v[40:41], s[50:51]
    v_pk_mul_f32 v[42:43], v[42:43], s[50:51]
    v_pk_mul_f32 v[44:45], v[44:45], s[50:51]
    v_pk_mul_f32 v[46:47], v[46:47], s[50:51]
    v_cvt_pk_bf16_f32 v40, v40, v41
    v_cvt_pk_bf16_f32 v41, v42, v43
    v_cvt_pk_bf16_f32 v42, v44, v45
    v_cvt_pk_bf16_f32 v43, v46, v47
    v_accvgpr_write_b32 a48, v40
    v_accvgpr_write_b32 a49, v41
    v_accvgpr_write_b32 a50, v42
    v_accvgpr_write_b32 a51, v43
    s_add_u32 m0, s36, 3072
    s_add_u32 s44, s35, 33792
    buffer_load_dwordx4 v254, s[4:7], s44 offen offset:0 nt lds
    s_waitcnt lgkmcnt(4)
    v_lshlrev_b32 v48, 16, v12
    v_and_b32 v49, s49, v12
    v_lshlrev_b32 v50, 16, v13
    v_and_b32 v51, s49, v13
    v_lshlrev_b32 v52, 16, v14
    v_and_b32 v53, s49, v14
    v_lshlrev_b32 v54, 16, v15
    v_and_b32 v55, s49, v15
    v_pk_mul_f32 v[48:49], v[48:49], s[50:51]
    v_pk_mul_f32 v[50:51], v[50:51], s[50:51]
    v_pk_mul_f32 v[52:53], v[52:53], s[50:51]
    v_pk_mul_f32 v[54:55], v[54:55], s[50:51]
    v_cvt_pk_bf16_f32 v48, v48, v49
    v_cvt_pk_bf16_f32 v49, v50, v51
    v_cvt_pk_bf16_f32 v50, v52, v53
    v_cvt_pk_bf16_f32 v51, v54, v55
    v_accvgpr_write_b32 a52, v48
    v_accvgpr_write_b32 a53, v49
    v_accvgpr_write_b32 a54, v50
    v_accvgpr_write_b32 a55, v51
    s_add_u32 m0, s36, 896
    s_add_u32 s44, s35, 30720
    buffer_load_dwordx4 v254, s[4:7], s44 offen offset:128 nt lds
    s_waitcnt lgkmcnt(3)
    v_lshlrev_b32 v40, 16, v16
    v_and_b32 v41, s49, v16
    v_lshlrev_b32 v42, 16, v17
    v_and_b32 v43, s49, v17
    v_lshlrev_b32 v44, 16, v18
    v_and_b32 v45, s49, v18
    v_lshlrev_b32 v46, 16, v19
    v_and_b32 v47, s49, v19
    v_pk_mul_f32 v[40:41], v[40:41], s[50:51]
    v_pk_mul_f32 v[42:43], v[42:43], s[50:51]
    v_pk_mul_f32 v[44:45], v[44:45], s[50:51]
    v_pk_mul_f32 v[46:47], v[46:47], s[50:51]
    v_cvt_pk_bf16_f32 v40, v40, v41
    v_cvt_pk_bf16_f32 v41, v42, v43
    v_cvt_pk_bf16_f32 v42, v44, v45
    v_cvt_pk_bf16_f32 v43, v46, v47
    v_accvgpr_write_b32 a56, v40
    v_accvgpr_write_b32 a57, v41
    v_accvgpr_write_b32 a58, v42
    v_accvgpr_write_b32 a59, v43
    s_add_u32 m0, s36, 3968
    s_add_u32 s44, s35, 33792
    buffer_load_dwordx4 v254, s[4:7], s44 offen offset:128 nt lds
    s_waitcnt lgkmcnt(2)
    v_lshlrev_b32 v48, 16, v20
    v_and_b32 v49, s49, v20
    v_lshlrev_b32 v50, 16, v21
    v_and_b32 v51, s49, v21
    v_lshlrev_b32 v52, 16, v22
    v_and_b32 v53, s49, v22
    v_lshlrev_b32 v54, 16, v23
    v_and_b32 v55, s49, v23
    v_pk_mul_f32 v[48:49], v[48:49], s[50:51]
    v_pk_mul_f32 v[50:51], v[50:51], s[50:51]
    v_pk_mul_f32 v[52:53], v[52:53], s[50:51]
    v_pk_mul_f32 v[54:55], v[54:55], s[50:51]
    v_cvt_pk_bf16_f32 v48, v48, v49
    v_cvt_pk_bf16_f32 v49, v50, v51
    v_cvt_pk_bf16_f32 v50, v52, v53
    v_cvt_pk_bf16_f32 v51, v54, v55
    v_accvgpr_write_b32 a60, v48
    v_accvgpr_write_b32 a61, v49
    v_accvgpr_write_b32 a62, v50
    v_accvgpr_write_b32 a63, v51
    s_add_u32 m0, s36, 1792
    s_add_u32 s44, s35, 30720
    buffer_load_dwordx4 v254, s[4:7], s44 offen offset:256 nt lds
    s_waitcnt lgkmcnt(1)
    v_lshlrev_b32 v40, 16, v24
    v_and_b32 v41, s49, v24
    v_lshlrev_b32 v42, 16, v25
    v_and_b32 v43, s49, v25
    v_lshlrev_b32 v44, 16, v26
    v_and_b32 v45, s49, v26
    v_lshlrev_b32 v46, 16, v27
    v_and_b32 v47, s49, v27
    v_pk_mul_f32 v[40:41], v[40:41], s[50:51]
    v_pk_mul_f32 v[42:43], v[42:43], s[50:51]
    v_pk_mul_f32 v[44:45], v[44:45], s[50:51]
    v_pk_mul_f32 v[46:47], v[46:47], s[50:51]
    v_cvt_pk_bf16_f32 v40, v40, v41
    v_cvt_pk_bf16_f32 v41, v42, v43
    v_cvt_pk_bf16_f32 v42, v44, v45
    v_cvt_pk_bf16_f32 v43, v46, v47
    v_accvgpr_write_b32 a64, v40
    v_accvgpr_write_b32 a65, v41
    v_accvgpr_write_b32 a66, v42
    v_accvgpr_write_b32 a67, v43
    s_add_u32 m0, s36, 4864
    s_add_u32 s44, s35, 33792
    buffer_load_dwordx4 v254, s[4:7], s44 offen offset:256 nt lds
    s_waitcnt lgkmcnt(0)
    v_lshlrev_b32 v48, 16, v28
    v_and_b32 v49, s49, v28
    v_lshlrev_b32 v50, 16, v29
    v_and_b32 v51, s49, v29
    v_lshlrev_b32 v52, 16, v30
    v_and_b32 v53, s49, v30
    v_lshlrev_b32 v54, 16, v31
    v_and_b32 v55, s49, v31
    v_pk_mul_f32 v[48:49], v[48:49], s[50:51]
    v_pk_mul_f32 v[50:51], v[50:51], s[50:51]
    v_pk_mul_f32 v[52:53], v[52:53], s[50:51]
    v_pk_mul_f32 v[54:55], v[54:55], s[50:51]
    v_cvt_pk_bf16_f32 v48, v48, v49
    v_cvt_pk_bf16_f32 v49, v50, v51
    v_cvt_pk_bf16_f32 v50, v52, v53
    v_cvt_pk_bf16_f32 v51, v54, v55
    v_accvgpr_write_b32 a68, v48
    v_accvgpr_write_b32 a69, v49
    v_accvgpr_write_b32 a70, v50
    v_accvgpr_write_b32 a71, v51
    s_waitcnt vmcnt(12)
    ds_read_b128 v[8:11], v0 offset:12288
    ds_read_b128 v[12:15], v1 offset:12288
    ds_read_b128 v[16:19], v0 offset:13312
    ds_read_b128 v[20:23], v1 offset:13312
    ds_read_b128 v[24:27], v0 offset:14336
    ds_read_b128 v[28:31], v1 offset:14336
    s_add_u32 m0, s26, 36864
    s_nop 0
    buffer_load_dwordx4 v254, s[12:15], s25 offen offset:0 nt lds
    s_waitcnt lgkmcnt(5)
    v_lshlrev_b32 v40, 16, v8
    v_and_b32 v41, s49, v8
    v_lshlrev_b32 v42, 16, v9
    v_and_b32 v43, s49, v9
    v_lshlrev_b32 v44, 16, v10
    v_and_b32 v45, s49, v10
    v_lshlrev_b32 v46, 16, v11
    v_and_b32 v47, s49, v11
    v_pk_mul_f32 v[40:41], v[40:41], s[50:51]
    v_pk_mul_f32 v[42:43], v[42:43], s[50:51]
    v_pk_mul_f32 v[44:45], v[44:45], s[50:51]
    v_pk_mul_f32 v[46:47], v[46:47], s[50:51]
    v_cvt_pk_bf16_f32 v40, v40, v41
    v_cvt_pk_bf16_f32 v41, v42, v43
    v_cvt_pk_bf16_f32 v42, v44, v45
    v_cvt_pk_bf16_f32 v43, v46, v47
    v_accvgpr_write_b32 a72, v40
    v_accvgpr_write_b32 a73, v41
    v_accvgpr_write_b32 a74, v42
    v_accvgpr_write_b32 a75, v43
    s_add_u32 m0, s26, 37760
    s_nop 0
    buffer_load_dwordx4 v254, s[12:15], s25 offen offset:128 nt lds
    s_waitcnt lgkmcnt(4)
    v_lshlrev_b32 v48, 16, v12
    v_and_b32 v49, s49, v12
    v_lshlrev_b32 v50, 16, v13
    v_and_b32 v51, s49, v13
    v_lshlrev_b32 v52, 16, v14
    v_and_b32 v53, s49, v14
    v_lshlrev_b32 v54, 16, v15
    v_and_b32 v55, s49, v15
    v_pk_mul_f32 v[48:49], v[48:49], s[50:51]
    v_pk_mul_f32 v[50:51], v[50:51], s[50:51]
    v_pk_mul_f32 v[52:53], v[52:53], s[50:51]
    v_pk_mul_f32 v[54:55], v[54:55], s[50:51]
    v_cvt_pk_bf16_f32 v48, v48, v49
    v_cvt_pk_bf16_f32 v49, v50, v51
    v_cvt_pk_bf16_f32 v50, v52, v53
    v_cvt_pk_bf16_f32 v51, v54, v55
    v_accvgpr_write_b32 a76, v48
    v_accvgpr_write_b32 a77, v49
    v_accvgpr_write_b32 a78, v50
    v_accvgpr_write_b32 a79, v51
    s_add_u32 m0, s26, 38656
    s_nop 0
    buffer_load_dwordx4 v254, s[12:15], s25 offen offset:256 nt lds
    s_waitcnt lgkmcnt(3)
    v_lshlrev_b32 v40, 16, v16
    v_and_b32 v41, s49, v16
    v_lshlrev_b32 v42, 16, v17
    v_and_b32 v43, s49, v17
    v_lshlrev_b32 v44, 16, v18
    v_and_b32 v45, s49, v18
    v_lshlrev_b32 v46, 16, v19
    v_and_b32 v47, s49, v19
    v_pk_mul_f32 v[40:41], v[40:41], s[50:51]
    v_pk_mul_f32 v[42:43], v[42:43], s[50:51]
    v_pk_mul_f32 v[44:45], v[44:45], s[50:51]
    v_pk_mul_f32 v[46:47], v[46:47], s[50:51]
    v_cvt_pk_bf16_f32 v40, v40, v41
    v_cvt_pk_bf16_f32 v41, v42, v43
    v_cvt_pk_bf16_f32 v42, v44, v45
    v_cvt_pk_bf16_f32 v43, v46, v47
    v_accvgpr_write_b32 a80, v40
    v_accvgpr_write_b32 a81, v41
    v_accvgpr_write_b32 a82, v42
    v_accvgpr_write_b32 a83, v43
    s_waitcnt lgkmcnt(2)
    v_lshlrev_b32 v48, 16, v20
    v_and_b32 v49, s49, v20
    v_lshlrev_b32 v50, 16, v21
    v_and_b32 v51, s49, v21
    v_lshlrev_b32 v52, 16, v22
    v_and_b32 v53, s49, v22
    v_lshlrev_b32 v54, 16, v23
    v_and_b32 v55, s49, v23
    v_pk_mul_f32 v[48:49], v[48:49], s[50:51]
    v_pk_mul_f32 v[50:51], v[50:51], s[50:51]
    v_pk_mul_f32 v[52:53], v[52:53], s[50:51]
    v_pk_mul_f32 v[54:55], v[54:55], s[50:51]
    v_cvt_pk_bf16_f32 v48, v48, v49
    v_cvt_pk_bf16_f32 v49, v50, v51
    v_cvt_pk_bf16_f32 v50, v52, v53
    v_cvt_pk_bf16_f32 v51, v54, v55
    v_accvgpr_write_b32 a84, v48
    v_accvgpr_write_b32 a85, v49
    v_accvgpr_write_b32 a86, v50
    v_accvgpr_write_b32 a87, v51
    s_waitcnt lgkmcnt(1)
    v_lshlrev_b32 v40, 16, v24
    v_and_b32 v41, s49, v24
    v_lshlrev_b32 v42, 16, v25
    v_and_b32 v43, s49, v25
    v_lshlrev_b32 v44, 16, v26
    v_and_b32 v45, s49, v26
    v_lshlrev_b32 v46, 16, v27
    v_and_b32 v47, s49, v27
    v_pk_mul_f32 v[40:41], v[40:41], s[50:51]
    v_pk_mul_f32 v[42:43], v[42:43], s[50:51]
    v_pk_mul_f32 v[44:45], v[44:45], s[50:51]
    v_pk_mul_f32 v[46:47], v[46:47], s[50:51]
    v_cvt_pk_bf16_f32 v40, v40, v41
    v_cvt_pk_bf16_f32 v41, v42, v43
    v_cvt_pk_bf16_f32 v42, v44, v45
    v_cvt_pk_bf16_f32 v43, v46, v47
    v_accvgpr_write_b32 a88, v40
    v_accvgpr_write_b32 a89, v41
    v_accvgpr_write_b32 a90, v42
    v_accvgpr_write_b32 a91, v43
    s_waitcnt lgkmcnt(0)
    v_lshlrev_b32 v48, 16, v28
    v_and_b32 v49, s49, v28
    v_lshlrev_b32 v50, 16, v29
    v_and_b32 v51, s49, v29
    v_lshlrev_b32 v52, 16, v30
    v_and_b32 v53, s49, v30
    v_lshlrev_b32 v54, 16, v31
    v_and_b32 v55, s49, v31
    v_pk_mul_f32 v[48:49], v[48:49], s[50:51]
    v_pk_mul_f32 v[50:51], v[50:51], s[50:51]
    v_pk_mul_f32 v[52:53], v[52:53], s[50:51]
    v_pk_mul_f32 v[54:55], v[54:55], s[50:51]
    v_cvt_pk_bf16_f32 v48, v48, v49
    v_cvt_pk_bf16_f32 v49, v50, v51
    v_cvt_pk_bf16_f32 v50, v52, v53
    v_cvt_pk_bf16_f32 v51, v54, v55
    v_accvgpr_write_b32 a92, v48
    v_accvgpr_write_b32 a93, v49
    v_accvgpr_write_b32 a94, v50
    v_accvgpr_write_b32 a95, v51
    s_waitcnt vmcnt(9)
    ds_read_b128 v[8:11], v2 offset:0
    ds_read_b128 v[12:15], v3 offset:0
    ds_read_b128 v[16:19], v2 offset:1024
    ds_read_b128 v[20:23], v3 offset:1024
    ds_read_b128 v[24:27], v2 offset:2048
    ds_read_b128 v[28:31], v3 offset:2048
    s_add_u32 m0, s26, 12288
    s_add_u32 s44, s25, 12288
    buffer_load_dwordx4 v254, s[8:11], s44 offen offset:0 nt lds
    s_waitcnt lgkmcnt(5)
    v_lshlrev_b32 v40, 16, v8
    v_and_b32 v41, s49, v8
    v_lshlrev_b32 v42, 16, v9
    v_and_b32 v43, s49, v9
    v_lshlrev_b32 v44, 16, v10
    v_and_b32 v45, s49, v10
    v_lshlrev_b32 v46, 16, v11
    v_and_b32 v47, s49, v11
    v_pk_mul_f32 v[40:41], v[40:41], s[50:51]
    v_pk_mul_f32 v[42:43], v[42:43], s[50:51]
    v_pk_mul_f32 v[44:45], v[44:45], s[50:51]
    v_pk_mul_f32 v[46:47], v[46:47], s[50:51]
    v_cvt_pk_bf16_f32 v40, v40, v41
    v_cvt_pk_bf16_f32 v41, v42, v43
    v_cvt_pk_bf16_f32 v42, v44, v45
    v_cvt_pk_bf16_f32 v43, v46, v47
    v_accvgpr_write_b32 a96, v40
    v_accvgpr_write_b32 a97, v41
    v_accvgpr_write_b32 a98, v42
    v_accvgpr_write_b32 a99, v43
    s_add_u32 m0, s26, 13184
    s_add_u32 s44, s25, 12288
    buffer_load_dwordx4 v254, s[8:11], s44 offen offset:128 nt lds
    s_waitcnt lgkmcnt(4)
    v_lshlrev_b32 v48, 16, v12
    v_and_b32 v49, s49, v12
    v_lshlrev_b32 v50, 16, v13
    v_and_b32 v51, s49, v13
    v_lshlrev_b32 v52, 16, v14
    v_and_b32 v53, s49, v14
    v_lshlrev_b32 v54, 16, v15
    v_and_b32 v55, s49, v15
    v_pk_mul_f32 v[48:49], v[48:49], s[50:51]
    v_pk_mul_f32 v[50:51], v[50:51], s[50:51]
    v_pk_mul_f32 v[52:53], v[52:53], s[50:51]
    v_pk_mul_f32 v[54:55], v[54:55], s[50:51]
    v_cvt_pk_bf16_f32 v48, v48, v49
    v_cvt_pk_bf16_f32 v49, v50, v51
    v_cvt_pk_bf16_f32 v50, v52, v53
    v_cvt_pk_bf16_f32 v51, v54, v55
    v_accvgpr_write_b32 a100, v48
    v_accvgpr_write_b32 a101, v49
    v_accvgpr_write_b32 a102, v50
    v_accvgpr_write_b32 a103, v51
    s_add_u32 m0, s26, 14080
    s_add_u32 s44, s25, 12288
    buffer_load_dwordx4 v254, s[8:11], s44 offen offset:256 nt lds
    s_waitcnt lgkmcnt(3)
    v_lshlrev_b32 v40, 16, v16
    v_and_b32 v41, s49, v16
    v_lshlrev_b32 v42, 16, v17
    v_and_b32 v43, s49, v17
    v_lshlrev_b32 v44, 16, v18
    v_and_b32 v45, s49, v18
    v_lshlrev_b32 v46, 16, v19
    v_and_b32 v47, s49, v19
    v_pk_mul_f32 v[40:41], v[40:41], s[50:51]
    v_pk_mul_f32 v[42:43], v[42:43], s[50:51]
    v_pk_mul_f32 v[44:45], v[44:45], s[50:51]
    v_pk_mul_f32 v[46:47], v[46:47], s[50:51]
    v_cvt_pk_bf16_f32 v40, v40, v41
    v_cvt_pk_bf16_f32 v41, v42, v43
    v_cvt_pk_bf16_f32 v42, v44, v45
    v_cvt_pk_bf16_f32 v43, v46, v47
    v_accvgpr_write_b32 a104, v40
    v_accvgpr_write_b32 a105, v41
    v_accvgpr_write_b32 a106, v42
    v_accvgpr_write_b32 a107, v43
    s_add_u32 m0, s26, 49152
    s_add_u32 s44, s25, 12288
    buffer_load_dwordx4 v254, s[12:15], s44 offen offset:0 nt lds
    s_waitcnt lgkmcnt(2)
    v_lshlrev_b32 v48, 16, v20
    v_and_b32 v49, s49, v20
    v_lshlrev_b32 v50, 16, v21
    v_and_b32 v51, s49, v21
    v_lshlrev_b32 v52, 16, v22
    v_and_b32 v53, s49, v22
    v_lshlrev_b32 v54, 16, v23
    v_and_b32 v55, s49, v23
    v_pk_mul_f32 v[48:49], v[48:49], s[50:51]
    v_pk_mul_f32 v[50:51], v[50:51], s[50:51]
    v_pk_mul_f32 v[52:53], v[52:53], s[50:51]
    v_pk_mul_f32 v[54:55], v[54:55], s[50:51]
    v_cvt_pk_bf16_f32 v48, v48, v49
    v_cvt_pk_bf16_f32 v49, v50, v51
    v_cvt_pk_bf16_f32 v50, v52, v53
    v_cvt_pk_bf16_f32 v51, v54, v55
    v_accvgpr_write_b32 a108, v48
    v_accvgpr_write_b32 a109, v49
    v_accvgpr_write_b32 a110, v50
    v_accvgpr_write_b32 a111, v51
    s_add_u32 m0, s26, 50048
    s_add_u32 s44, s25, 12288
    buffer_load_dwordx4 v254, s[12:15], s44 offen offset:128 nt lds
    s_waitcnt lgkmcnt(1)
    v_lshlrev_b32 v40, 16, v24
    v_and_b32 v41, s49, v24
    v_lshlrev_b32 v42, 16, v25
    v_and_b32 v43, s49, v25
    v_lshlrev_b32 v44, 16, v26
    v_and_b32 v45, s49, v26
    v_lshlrev_b32 v46, 16, v27
    v_and_b32 v47, s49, v27
    v_pk_mul_f32 v[40:41], v[40:41], s[50:51]
    v_pk_mul_f32 v[42:43], v[42:43], s[50:51]
    v_pk_mul_f32 v[44:45], v[44:45], s[50:51]
    v_pk_mul_f32 v[46:47], v[46:47], s[50:51]
    v_cvt_pk_bf16_f32 v40, v40, v41
    v_cvt_pk_bf16_f32 v41, v42, v43
    v_cvt_pk_bf16_f32 v42, v44, v45
    v_cvt_pk_bf16_f32 v43, v46, v47
    v_accvgpr_write_b32 a112, v40
    v_accvgpr_write_b32 a113, v41
    v_accvgpr_write_b32 a114, v42
    v_accvgpr_write_b32 a115, v43
    s_add_u32 m0, s26, 50944
    s_add_u32 s44, s25, 12288
    buffer_load_dwordx4 v254, s[12:15], s44 offen offset:256 nt lds
    s_waitcnt lgkmcnt(0)
    v_lshlrev_b32 v48, 16, v28
    v_and_b32 v49, s49, v28
    v_lshlrev_b32 v50, 16, v29
    v_and_b32 v51, s49, v29
    v_lshlrev_b32 v52, 16, v30
    v_and_b32 v53, s49, v30
    v_lshlrev_b32 v54, 16, v31
    v_and_b32 v55, s49, v31
    v_pk_mul_f32 v[48:49], v[48:49], s[50:51]
    v_pk_mul_f32 v[50:51], v[50:51], s[50:51]
    v_pk_mul_f32 v[52:53], v[52:53], s[50:51]
    v_pk_mul_f32 v[54:55], v[54:55], s[50:51]
    v_cvt_pk_bf16_f32 v48, v48, v49
    v_cvt_pk_bf16_f32 v49, v50, v51
    v_cvt_pk_bf16_f32 v50, v52, v53
    v_cvt_pk_bf16_f32 v51, v54, v55
    v_accvgpr_write_b32 a116, v48
    v_accvgpr_write_b32 a117, v49
    v_accvgpr_write_b32 a118, v50
    v_accvgpr_write_b32 a119, v51
    s_add_u32 s25, s25, 24576
    ds_read_b128 a[144:147], v252 offset:0
    ds_read_b128 a[148:151], v252 offset:1024
    ds_read_b128 a[152:155], v252 offset:2048
    v_xor_b32 v252, 64, v252
    ds_read_b128 a[156:159], v252 offset:0
    ds_read_b128 a[160:163], v252 offset:1024
    ds_read_b128 a[164:167], v252 offset:2048
    s_waitcnt lgkmcnt(1)
    v_mfma_f32_16x16x32_bf16 v[212:215], a[144:147], a[0:3], 0
    v_mfma_f32_16x16x32_bf16 v[212:215], a[148:151], a[8:11], v[212:215]
    v_mfma_f32_16x16x32_bf16 v[212:215], a[152:155], a[16:19], v[212:215]
    v_mfma_f32_16x16x32_bf16 v[212:215], a[156:159], a[4:7], v[212:215]
    v_mfma_f32_16x16x32_bf16 v[212:215], a[160:163], a[12:15], v[212:215]
    s_waitcnt lgkmcnt(0)
    v_mfma_f32_16x16x32_bf16 v[212:215], a[164:167], a[20:23], v[212:215]
    v_mfma_f32_16x16x32_bf16 v[216:219], a[144:147], a[24:27], 0
    v_mfma_f32_16x16x32_bf16 v[216:219], a[148:151], a[32:35], v[216:219]
    v_exp_f32 v212, v212
    v_mfma_f32_16x16x32_bf16 v[216:219], a[152:155], a[40:43], v[216:219]
    v_exp_f32 v213, v213
    v_mfma_f32_16x16x32_bf16 v[216:219], a[156:159], a[28:31], v[216:219]
    v_mov_b32 v204, v212
    v_add_f32 v204, v204, v213
    v_mfma_f32_16x16x32_bf16 v[216:219], a[160:163], a[36:39], v[216:219]
    v_exp_f32 v214, v214
    v_mfma_f32_16x16x32_bf16 v[216:219], a[164:167], a[44:47], v[216:219]
    v_add_f32 v204, v204, v214
    v_cvt_pk_bf16_f32 v212, v212, v213
    v_mfma_f32_16x16x32_bf16 v[220:223], a[144:147], a[48:51], 0
    v_exp_f32 v215, v215
    v_mfma_f32_16x16x32_bf16 v[220:223], a[148:151], a[56:59], v[220:223]
    v_add_f32 v204, v204, v215
    v_cvt_pk_bf16_f32 v213, v214, v215
    v_mfma_f32_16x16x32_bf16 v[220:223], a[152:155], a[64:67], v[220:223]
    v_exp_f32 v216, v216
    v_mfma_f32_16x16x32_bf16 v[220:223], a[156:159], a[52:55], v[220:223]
    v_exp_f32 v217, v217
    v_mfma_f32_16x16x32_bf16 v[220:223], a[160:163], a[60:63], v[220:223]
    v_mov_b32 v205, v216
    v_add_f32 v205, v205, v217
    v_mfma_f32_16x16x32_bf16 v[220:223], a[164:167], a[68:71], v[220:223]
    v_exp_f32 v218, v218
    v_mfma_f32_16x16x32_bf16 v[224:227], a[144:147], a[72:75], 0
    v_add_f32 v205, v205, v218
    v_cvt_pk_bf16_f32 v216, v216, v217
    v_mfma_f32_16x16x32_bf16 v[224:227], a[148:151], a[80:83], v[224:227]
    v_exp_f32 v219, v219
    v_mfma_f32_16x16x32_bf16 v[224:227], a[152:155], a[88:91], v[224:227]
    v_add_f32 v205, v205, v219
    v_cvt_pk_bf16_f32 v217, v218, v219
    v_mfma_f32_16x16x32_bf16 v[224:227], a[156:159], a[76:79], v[224:227]
    v_exp_f32 v220, v220
    v_mfma_f32_16x16x32_bf16 v[224:227], a[160:163], a[84:87], v[224:227]
    v_exp_f32 v221, v221
    v_mfma_f32_16x16x32_bf16 v[224:227], a[164:167], a[92:95], v[224:227]
    v_mov_b32 v206, v220
    v_add_f32 v206, v206, v221
    v_mfma_f32_16x16x32_bf16 v[228:231], a[144:147], a[96:99], 0
    v_exp_f32 v222, v222
    v_mfma_f32_16x16x32_bf16 v[228:231], a[148:151], a[104:107], v[228:231]
    v_add_f32 v206, v206, v222
    v_cvt_pk_bf16_f32 v220, v220, v221
    v_mfma_f32_16x16x32_bf16 v[228:231], a[152:155], a[112:115], v[228:231]
    v_exp_f32 v223, v223
    v_mfma_f32_16x16x32_bf16 v[228:231], a[156:159], a[100:103], v[228:231]
    v_exp_f32 v224, v224
    v_mfma_f32_16x16x32_bf16 v[228:231], a[160:163], a[108:111], v[228:231]
    s_waitcnt vmcnt(13)
    ds_read_b128 v[8:11], v0 offset:0
    ds_read_b128 v[12:15], v1 offset:0
    s_waitcnt lgkmcnt(1)
    v_lshlrev_b32 v40, 16, v8
    v_and_b32 v41, s49, v8
    v_lshlrev_b32 v42, 16, v9
    v_and_b32 v43, s49, v9
    v_lshlrev_b32 v44, 16, v10
    v_and_b32 v45, s49, v10
    v_lshlrev_b32 v46, 16, v11
    v_and_b32 v47, s49, v11
    v_pk_mul_f32 v[40:41], v[40:41], s[50:51]
    v_pk_mul_f32 v[42:43], v[42:43], s[50:51]
    v_pk_mul_f32 v[44:45], v[44:45], s[50:51]
    v_pk_mul_f32 v[46:47], v[46:47], s[50:51]
    v_cvt_pk_bf16_f32 v40, v40, v41
    v_cvt_pk_bf16_f32 v41, v42, v43
    v_cvt_pk_bf16_f32 v42, v44, v45
    v_cvt_pk_bf16_f32 v43, v46, v47
    v_accvgpr_write_b32 a120, v40
    v_accvgpr_write_b32 a121, v41
    v_accvgpr_write_b32 a122, v42
    v_accvgpr_write_b32 a123, v43
    s_waitcnt lgkmcnt(0)
    v_lshlrev_b32 v48, 16, v12
    v_and_b32 v49, s49, v12
    v_lshlrev_b32 v50, 16, v13
    v_and_b32 v51, s49, v13
    v_lshlrev_b32 v52, 16, v14
    v_and_b32 v53, s49, v14
    v_lshlrev_b32 v54, 16, v15
    v_and_b32 v55, s49, v15
    v_pk_mul_f32 v[48:49], v[48:49], s[50:51]
    v_pk_mul_f32 v[50:51], v[50:51], s[50:51]
    v_pk_mul_f32 v[52:53], v[52:53], s[50:51]
    v_pk_mul_f32 v[54:55], v[54:55], s[50:51]
    v_cvt_pk_bf16_f32 v48, v48, v49
    v_cvt_pk_bf16_f32 v49, v50, v51
    v_cvt_pk_bf16_f32 v50, v52, v53
    v_cvt_pk_bf16_f32 v51, v54, v55
    v_accvgpr_write_b32 a124, v48
    v_accvgpr_write_b32 a125, v49
    v_accvgpr_write_b32 a126, v50
    v_accvgpr_write_b32 a127, v51
    s_waitcnt vmcnt(11)
    ds_read_b128 v[16:19], v0 offset:1024
    ds_read_b128 v[20:23], v1 offset:1024
    s_waitcnt lgkmcnt(1)
    v_lshlrev_b32 v40, 16, v16
    v_and_b32 v41, s49, v16
    v_lshlrev_b32 v42, 16, v17
    v_and_b32 v43, s49, v17
    v_lshlrev_b32 v44, 16, v18
    v_and_b32 v45, s49, v18
    v_lshlrev_b32 v46, 16, v19
    v_and_b32 v47, s49, v19
    v_pk_mul_f32 v[40:41], v[40:41], s[50:51]
    v_pk_mul_f32 v[42:43], v[42:43], s[50:51]
    v_pk_mul_f32 v[44:45], v[44:45], s[50:51]
    v_pk_mul_f32 v[46:47], v[46:47], s[50:51]
    v_cvt_pk_bf16_f32 v40, v40, v41
    v_cvt_pk_bf16_f32 v41, v42, v43
    v_cvt_pk_bf16_f32 v42, v44, v45
    v_cvt_pk_bf16_f32 v43, v46, v47
    v_accvgpr_write_b32 a128, v40
    v_accvgpr_write_b32 a129, v41
    v_accvgpr_write_b32 a130, v42
    v_accvgpr_write_b32 a131, v43
    s_waitcnt lgkmcnt(0)
    v_lshlrev_b32 v48, 16, v20
    v_and_b32 v49, s49, v20
    v_lshlrev_b32 v50, 16, v21
    v_and_b32 v51, s49, v21
    v_lshlrev_b32 v52, 16, v22
    v_and_b32 v53, s49, v22
    v_lshlrev_b32 v54, 16, v23
    v_and_b32 v55, s49, v23
    v_pk_mul_f32 v[48:49], v[48:49], s[50:51]
    v_pk_mul_f32 v[50:51], v[50:51], s[50:51]
    v_pk_mul_f32 v[52:53], v[52:53], s[50:51]
    v_pk_mul_f32 v[54:55], v[54:55], s[50:51]
    v_cvt_pk_bf16_f32 v48, v48, v49
    v_cvt_pk_bf16_f32 v49, v50, v51
    v_cvt_pk_bf16_f32 v50, v52, v53
    v_cvt_pk_bf16_f32 v51, v54, v55
    v_accvgpr_write_b32 a132, v48
    v_accvgpr_write_b32 a133, v49
    v_accvgpr_write_b32 a134, v50
    v_accvgpr_write_b32 a135, v51
    s_waitcnt vmcnt(9)
    ds_read_b128 v[24:27], v0 offset:2048
    ds_read_b128 v[28:31], v1 offset:2048
    s_waitcnt lgkmcnt(1)
    v_lshlrev_b32 v40, 16, v24
    v_and_b32 v41, s49, v24
    v_lshlrev_b32 v42, 16, v25
    v_and_b32 v43, s49, v25
    v_lshlrev_b32 v44, 16, v26
    v_and_b32 v45, s49, v26
    v_lshlrev_b32 v46, 16, v27
    v_and_b32 v47, s49, v27
    v_pk_mul_f32 v[40:41], v[40:41], s[50:51]
    v_pk_mul_f32 v[42:43], v[42:43], s[50:51]
    v_pk_mul_f32 v[44:45], v[44:45], s[50:51]
    v_pk_mul_f32 v[46:47], v[46:47], s[50:51]
    v_cvt_pk_bf16_f32 v40, v40, v41
    v_cvt_pk_bf16_f32 v41, v42, v43
    v_cvt_pk_bf16_f32 v42, v44, v45
    v_cvt_pk_bf16_f32 v43, v46, v47
    v_accvgpr_write_b32 a136, v40
    v_accvgpr_write_b32 a137, v41
    v_accvgpr_write_b32 a138, v42
    v_accvgpr_write_b32 a139, v43
    s_waitcnt lgkmcnt(0)
    v_lshlrev_b32 v48, 16, v28
    v_and_b32 v49, s49, v28
    v_lshlrev_b32 v50, 16, v29
    v_and_b32 v51, s49, v29
    v_lshlrev_b32 v52, 16, v30
    v_and_b32 v53, s49, v30
    v_lshlrev_b32 v54, 16, v31
    v_and_b32 v55, s49, v31
    v_pk_mul_f32 v[48:49], v[48:49], s[50:51]
    v_pk_mul_f32 v[50:51], v[50:51], s[50:51]
    v_pk_mul_f32 v[52:53], v[52:53], s[50:51]
    v_pk_mul_f32 v[54:55], v[54:55], s[50:51]
    v_cvt_pk_bf16_f32 v48, v48, v49
    v_cvt_pk_bf16_f32 v49, v50, v51
    v_cvt_pk_bf16_f32 v50, v52, v53
    v_cvt_pk_bf16_f32 v51, v54, v55
    v_accvgpr_write_b32 a140, v48
    v_accvgpr_write_b32 a141, v49
    v_accvgpr_write_b32 a142, v50
    v_accvgpr_write_b32 a143, v51
    s_nop 1
    v_mfma_f32_16x16x32_bf16 v[228:231], a[164:167], a[116:119], v[228:231]
    v_exp_f32 v225, v225
    v_mfma_f32_16x16x32_bf16 v[232:235], a[144:147], a[120:123], 0
    ds_read_b128 a[144:147], v252 offset:6144
    v_add_f32 v206, v206, v223
    v_mfma_f32_16x16x32_bf16 v[232:235], a[148:151], a[128:131], v[232:235]
    ds_read_b128 a[148:151], v252 offset:7168
    v_cvt_pk_bf16_f32 v221, v222, v223
    v_mfma_f32_16x16x32_bf16 v[232:235], a[152:155], a[136:139], v[232:235]
    ds_read_b128 a[152:155], v252 offset:8192
    v_xor_b32 v252, 64, v252
    v_mfma_f32_16x16x32_bf16 v[232:235], a[156:159], a[124:127], v[232:235]
    ds_read_b128 a[156:159], v252 offset:6144
    v_mov_b32 v207, v224
    v_mfma_f32_16x16x32_bf16 v[232:235], a[160:163], a[132:135], v[232:235]
    ds_read_b128 a[160:163], v252 offset:7168
    v_add_f32 v207, v207, v225
    v_mfma_f32_16x16x32_bf16 v[232:235], a[164:167], a[140:143], v[232:235]
    s_waitcnt lgkmcnt(4)
    ds_read_b128 a[164:167], v252 offset:8192
    v_cvt_pk_bf16_f32 v224, v224, v225
    v_mfma_f32_16x16x32_bf16 v[236:239], a[144:147], a[4:7], 0
    s_waitcnt lgkmcnt(4)
    v_exp_f32 v226, v226
    v_mfma_f32_16x16x32_bf16 v[236:239], a[148:151], a[12:15], v[236:239]
    s_waitcnt lgkmcnt(3)
    v_exp_f32 v227, v227
    v_mfma_f32_16x16x32_bf16 v[236:239], a[152:155], a[20:23], v[236:239]
    s_waitcnt lgkmcnt(2)
    v_add_f32 v207, v207, v226
    v_add_f32 v207, v207, v227
    v_mfma_f32_16x16x32_bf16 v[236:239], a[156:159], a[0:3], v[236:239]
    s_waitcnt lgkmcnt(1)
    v_exp_f32 v228, v228
    v_mfma_f32_16x16x32_bf16 v[236:239], a[160:163], a[8:11], v[236:239]
    s_waitcnt lgkmcnt(0)
    v_mov_b32 v208, v228
    v_cvt_pk_bf16_f32 v225, v226, v227
    v_mfma_f32_16x16x32_bf16 v[236:239], a[164:167], a[16:19], v[236:239]
    v_exp_f32 v229, v229
    v_mfma_f32_16x16x32_bf16 v[240:243], a[144:147], a[28:31], 0
    v_add_f32 v208, v208, v229
    v_cvt_pk_bf16_f32 v228, v228, v229
    v_mfma_f32_16x16x32_bf16 v[240:243], a[148:151], a[36:39], v[240:243]
    v_exp_f32 v230, v230
    v_mfma_f32_16x16x32_bf16 v[240:243], a[152:155], a[44:47], v[240:243]
    v_exp_f32 v231, v231
    v_mfma_f32_16x16x32_bf16 v[240:243], a[156:159], a[24:27], v[240:243]
    v_add_f32 v208, v208, v230
    v_add_f32 v208, v208, v231
    v_mfma_f32_16x16x32_bf16 v[240:243], a[160:163], a[32:35], v[240:243]
    v_exp_f32 v232, v232
    v_mfma_f32_16x16x32_bf16 v[240:243], a[164:167], a[40:43], v[240:243]
    v_mov_b32 v209, v232
    v_cvt_pk_bf16_f32 v229, v230, v231
    v_mfma_f32_16x16x32_bf16 v[244:247], a[144:147], a[52:55], 0
    v_exp_f32 v233, v233
    v_mfma_f32_16x16x32_bf16 v[244:247], a[148:151], a[60:63], v[244:247]
    v_add_f32 v209, v209, v233
    v_cvt_pk_bf16_f32 v232, v232, v233
    v_mfma_f32_16x16x32_bf16 v[244:247], a[152:155], a[68:71], v[244:247]
    v_exp_f32 v234, v234
    v_mfma_f32_16x16x32_bf16 v[244:247], a[156:159], a[48:51], v[244:247]
    v_exp_f32 v235, v235
    v_mfma_f32_16x16x32_bf16 v[244:247], a[160:163], a[56:59], v[244:247]
    v_add_f32 v209, v209, v234
    v_add_f32 v209, v209, v235
    v_mfma_f32_16x16x32_bf16 v[244:247], a[164:167], a[64:67], v[244:247]
    v_exp_f32 v236, v236
    v_mfma_f32_16x16x32_bf16 v[248:251], a[144:147], a[76:79], 0
    v_add_f32 v204, v204, v236
    v_cvt_pk_bf16_f32 v233, v234, v235
    v_mfma_f32_16x16x32_bf16 v[248:251], a[148:151], a[84:87], v[248:251]
    v_exp_f32 v237, v237
    v_mfma_f32_16x16x32_bf16 v[248:251], a[152:155], a[92:95], v[248:251]
    v_add_f32 v204, v204, v237
    v_cvt_pk_bf16_f32 v214, v236, v237
    v_mfma_f32_16x16x32_bf16 v[248:251], a[156:159], a[72:75], v[248:251]
    v_exp_f32 v238, v238
    v_mfma_f32_16x16x32_bf16 v[248:251], a[160:163], a[80:83], v[248:251]
    v_exp_f32 v239, v239
    v_mfma_f32_16x16x32_bf16 v[248:251], a[164:167], a[88:91], v[248:251]
    v_add_f32 v204, v204, v238
    v_add_f32 v204, v204, v239
    v_cvt_pk_bf16_f32 v215, v238, v239
    v_mfma_f32_16x16x32_bf16 v[236:239], a[144:147], a[100:103], 0
    v_exp_f32 v240, v240
    v_mfma_f32_16x16x32_bf16 v[236:239], a[148:151], a[108:111], v[236:239]
    v_exp_f32 v241, v241
    v_mfma_f32_16x16x32_bf16 v[236:239], a[152:155], a[116:119], v[236:239]
    v_add_f32 v205, v205, v240
    v_cvt_pk_bf16_f32 v218, v240, v241
    v_mfma_f32_16x16x32_bf16 v[236:239], a[156:159], a[96:99], v[236:239]
    v_exp_f32 v242, v242
    v_mfma_f32_16x16x32_bf16 v[236:239], a[160:163], a[104:107], v[236:239]
    s_waitcnt vmcnt(6)
    v_exp_f32 v243, v243
    v_mfma_f32_16x16x32_bf16 v[236:239], a[164:167], a[112:115], v[236:239]
    s_barrier
    v_add_f32 v205, v205, v241
    v_add_f32 v205, v205, v242
    v_add_f32 v205, v205, v243
    v_cvt_pk_bf16_f32 v219, v242, v243
    v_mfma_f32_16x16x32_bf16 v[240:243], a[144:147], a[124:127], 0
    ds_read_b64_tr_b16 a[144:145], v253 offset:0
    v_mfma_f32_16x16x32_bf16 v[240:243], a[148:151], a[132:135], v[240:243]
    ds_read_b64_tr_b16 a[146:147], v253 offset:6144
    v_mfma_f32_16x16x32_bf16 v[240:243], a[152:155], a[140:143], v[240:243]
    ds_read_b64_tr_b16 a[148:149], v253 offset:1024
    v_mfma_f32_16x16x32_bf16 v[240:243], a[156:159], a[120:123], v[240:243]
    ds_read_b64_tr_b16 a[150:151], v253 offset:7168
    v_mfma_f32_16x16x32_bf16 v[240:243], a[160:163], a[128:131], v[240:243]
    ds_read_b64_tr_b16 a[152:153], v253 offset:2048
    v_mfma_f32_16x16x32_bf16 v[240:243], a[164:167], a[136:139], v[240:243]
    s_waitcnt lgkmcnt(3)
    ds_read_b64_tr_b16 a[154:155], v253 offset:8192
    v_xor_b32 v253, 32, v253
    v_mfma_f32_16x16x32_bf16 v[0:3], a[144:147], v[212:215], 0
    ds_read_b64_tr_b16 a[156:157], v253 offset:0
    v_mfma_f32_16x16x32_bf16 v[48:51], a[144:147], v[216:219], 0
    s_waitcnt lgkmcnt(3)
    ds_read_b64_tr_b16 a[158:159], v253 offset:6144
    v_mfma_f32_16x16x32_bf16 v[16:19], a[148:151], v[212:215], 0
    ds_read_b64_tr_b16 a[160:161], v253 offset:1024
    v_mfma_f32_16x16x32_bf16 v[64:67], a[148:151], v[216:219], 0
    s_waitcnt lgkmcnt(3)
    ds_read_b64_tr_b16 a[162:163], v253 offset:7168
    v_mfma_f32_16x16x32_bf16 v[32:35], a[152:155], v[212:215], 0
    ds_read_b64_tr_b16 a[164:165], v253 offset:2048
    v_mfma_f32_16x16x32_bf16 v[80:83], a[152:155], v[216:219], 0
    s_waitcnt lgkmcnt(3)
    ds_read_b64_tr_b16 a[166:167], v253 offset:8192
    v_xor_b32 v253, 64, v253
    v_mfma_f32_16x16x32_bf16 v[4:7], a[156:159], v[212:215], 0
    v_exp_f32 v244, v244
    v_mfma_f32_16x16x32_bf16 v[52:55], a[156:159], v[216:219], 0
    s_waitcnt lgkmcnt(2)
    v_exp_f32 v245, v245
    v_mfma_f32_16x16x32_bf16 v[20:23], a[160:163], v[212:215], 0
    v_exp_f32 v246, v246
    v_mfma_f32_16x16x32_bf16 v[68:71], a[160:163], v[216:219], 0
    s_waitcnt lgkmcnt(0)
    v_exp_f32 v247, v247
    v_mfma_f32_16x16x32_bf16 v[36:39], a[164:167], v[212:215], 0
    v_cvt_pk_bf16_f32 v222, v244, v245
    v_cvt_pk_bf16_f32 v223, v246, v247
    v_mfma_f32_16x16x32_bf16 v[84:87], a[164:167], v[216:219], 0
    v_add_f32 v206, v206, v244
    v_add_f32 v206, v206, v245
    v_mfma_f32_16x16x32_bf16 v[96:99], a[144:147], v[220:223], 0
    v_exp_f32 v248, v248
    v_mfma_f32_16x16x32_bf16 v[112:115], a[148:151], v[220:223], 0
    v_exp_f32 v249, v249
    v_mfma_f32_16x16x32_bf16 v[128:131], a[152:155], v[220:223], 0
    v_exp_f32 v250, v250
    v_mfma_f32_16x16x32_bf16 v[100:103], a[156:159], v[220:223], 0
    v_exp_f32 v251, v251
    v_mfma_f32_16x16x32_bf16 v[116:119], a[160:163], v[220:223], 0
    v_cvt_pk_bf16_f32 v226, v248, v249
    v_cvt_pk_bf16_f32 v227, v250, v251
    v_mfma_f32_16x16x32_bf16 v[132:135], a[164:167], v[220:223], 0
    v_add_f32 v206, v206, v246
    v_add_f32 v206, v206, v247
    v_mfma_f32_16x16x32_bf16 v[144:147], a[144:147], v[224:227], 0
    v_exp_f32 v236, v236
    v_mfma_f32_16x16x32_bf16 v[160:163], a[148:151], v[224:227], 0
    v_exp_f32 v237, v237
    v_mfma_f32_16x16x32_bf16 v[176:179], a[152:155], v[224:227], 0
    v_exp_f32 v238, v238
    v_mfma_f32_16x16x32_bf16 v[148:151], a[156:159], v[224:227], 0
    v_exp_f32 v239, v239
    v_mfma_f32_16x16x32_bf16 v[164:167], a[160:163], v[224:227], 0
    v_cvt_pk_bf16_f32 v230, v236, v237
    v_cvt_pk_bf16_f32 v231, v238, v239
    v_mfma_f32_16x16x32_bf16 v[180:183], a[164:167], v[224:227], 0
    v_add_f32 v207, v207, v248
    v_add_f32 v207, v207, v249
    v_mfma_f32_16x16x32_bf16 v[192:195], a[144:147], v[228:231], 0
    v_exp_f32 v240, v240
    v_mfma_f32_16x16x32_bf16 a[172:175], a[148:151], v[228:231], 0
    v_exp_f32 v241, v241
    v_mfma_f32_16x16x32_bf16 a[192:195], a[152:155], v[228:231], 0
    v_exp_f32 v242, v242
    v_mfma_f32_16x16x32_bf16 v[196:199], a[156:159], v[228:231], 0
    v_exp_f32 v243, v243
    v_mfma_f32_16x16x32_bf16 a[180:183], a[160:163], v[228:231], 0
    v_cvt_pk_bf16_f32 v234, v240, v241
    v_cvt_pk_bf16_f32 v235, v242, v243
    v_mfma_f32_16x16x32_bf16 a[196:199], a[164:167], v[228:231], 0
    v_add_f32 v207, v207, v250
    v_add_f32 v207, v207, v251
    v_mfma_f32_16x16x32_bf16 a[208:211], a[144:147], v[232:235], 0
    ds_read_b64_tr_b16 a[144:145], v253 offset:0
    v_add_f32 v208, v208, v236
    v_mfma_f32_16x16x32_bf16 a[224:227], a[148:151], v[232:235], 0
    ds_read_b64_tr_b16 a[146:147], v253 offset:6144
    v_add_f32 v208, v208, v237
    v_mfma_f32_16x16x32_bf16 a[240:243], a[152:155], v[232:235], 0
    ds_read_b64_tr_b16 a[148:149], v253 offset:1024
    v_add_f32 v208, v208, v238
    v_mfma_f32_16x16x32_bf16 a[212:215], a[156:159], v[232:235], 0
    ds_read_b64_tr_b16 a[150:151], v253 offset:7168
    v_add_f32 v208, v208, v239
    v_mfma_f32_16x16x32_bf16 a[228:231], a[160:163], v[232:235], 0
    ds_read_b64_tr_b16 a[152:153], v253 offset:2048
    v_add_f32 v209, v209, v240
    v_mfma_f32_16x16x32_bf16 a[244:247], a[164:167], v[232:235], 0
    s_waitcnt lgkmcnt(3)
    ds_read_b64_tr_b16 a[154:155], v253 offset:8192
    v_xor_b32 v253, 32, v253
    v_mfma_f32_16x16x32_bf16 v[12:15], a[144:147], v[212:215], 0
    ds_read_b64_tr_b16 a[156:157], v253 offset:0
    v_add_f32 v209, v209, v241
    v_mfma_f32_16x16x32_bf16 v[60:63], a[144:147], v[216:219], 0
    ds_read_b64_tr_b16 a[158:159], v253 offset:6144
    v_add_f32 v209, v209, v242
    v_mfma_f32_16x16x32_bf16 v[108:111], a[144:147], v[220:223], 0
    ds_read_b64_tr_b16 a[160:161], v253 offset:1024
    v_add_f32 v209, v209, v243
    v_mfma_f32_16x16x32_bf16 v[156:159], a[144:147], v[224:227], 0
    ds_read_b64_tr_b16 a[162:163], v253 offset:7168
    v_mfma_f32_16x16x32_bf16 a[168:171], a[144:147], v[228:231], 0
    ds_read_b64_tr_b16 a[164:165], v253 offset:2048
    v_add_u32 v252, s27, v252
    v_mfma_f32_16x16x32_bf16 a[220:223], a[144:147], v[232:235], 0
    s_waitcnt lgkmcnt(7)
    ds_read_b64_tr_b16 a[166:167], v253 offset:8192
    v_xad_u32 v253, v253, 64, s27
    v_mfma_f32_16x16x32_bf16 v[28:31], a[148:151], v[212:215], 0
    v_mfma_f32_16x16x32_bf16 v[76:79], a[148:151], v[216:219], 0
    v_mfma_f32_16x16x32_bf16 v[124:127], a[148:151], v[220:223], 0
    v_mfma_f32_16x16x32_bf16 v[172:175], a[148:151], v[224:227], 0
    s_waitcnt vmcnt(0) lgkmcnt(0)
    v_mfma_f32_16x16x32_bf16 a[188:191], a[148:151], v[228:231], 0
    s_barrier
    v_mfma_f32_16x16x32_bf16 a[236:239], a[148:151], v[232:235], 0
    ds_read_b128 a[144:147], v252 offset:0
    v_mfma_f32_16x16x32_bf16 v[44:47], a[152:155], v[212:215], 0
    ds_read_b128 a[148:151], v252 offset:1024
    v_mfma_f32_16x16x32_bf16 v[92:95], a[152:155], v[216:219], 0
    s_mov_b32 m0, s26
    v_mfma_f32_16x16x32_bf16 v[140:143], a[152:155], v[220:223], 0
    buffer_load_dwordx4 v254, s[8:11], s25 offen offset:0 nt lds
    v_mfma_f32_16x16x32_bf16 v[188:191], a[152:155], v[224:227], 0
    s_add_u32 m0, s26, 896
    v_mfma_f32_16x16x32_bf16 a[204:207], a[152:155], v[228:231], 0
    buffer_load_dwordx4 v254, s[8:11], s25 offen offset:128 nt lds
    v_mfma_f32_16x16x32_bf16 a[252:255], a[152:155], v[232:235], 0
    ds_read_b128 a[152:155], v252 offset:2048
    v_xor_b32 v252, 64, v252
    v_mfma_f32_16x16x32_bf16 v[8:11], a[156:159], v[212:215], 0
    s_add_u32 m0, s26, 1792
    v_mfma_f32_16x16x32_bf16 v[56:59], a[156:159], v[216:219], 0
    buffer_load_dwordx4 v254, s[8:11], s25 offen offset:256 nt lds
    v_mfma_f32_16x16x32_bf16 v[104:107], a[156:159], v[220:223], 0
    s_add_u32 m0, s26, 36864
    v_mfma_f32_16x16x32_bf16 v[152:155], a[156:159], v[224:227], 0
    buffer_load_dwordx4 v254, s[12:15], s25 offen offset:0 nt lds
    v_mfma_f32_16x16x32_bf16 v[200:203], a[156:159], v[228:231], 0
    s_sub_u32 s33, s33, 1
    v_mfma_f32_16x16x32_bf16 a[216:219], a[156:159], v[232:235], 0
    ds_read_b128 a[156:159], v252 offset:0
    v_mfma_f32_16x16x32_bf16 v[24:27], a[160:163], v[212:215], 0
    s_add_u32 m0, s26, 37760
    v_mfma_f32_16x16x32_bf16 v[72:75], a[160:163], v[216:219], 0
    buffer_load_dwordx4 v254, s[12:15], s25 offen offset:128 nt lds
    v_mfma_f32_16x16x32_bf16 v[120:123], a[160:163], v[220:223], 0
    s_add_u32 m0, s26, 38656
    v_mfma_f32_16x16x32_bf16 v[168:171], a[160:163], v[224:227], 0
    buffer_load_dwordx4 v254, s[12:15], s25 offen offset:256 nt lds
    v_mfma_f32_16x16x32_bf16 a[184:187], a[160:163], v[228:231], 0
    s_add_u32 s26, s26, s27
    v_mfma_f32_16x16x32_bf16 a[232:235], a[160:163], v[232:235], 0
    ds_read_b128 a[160:163], v252 offset:1024
    v_mfma_f32_16x16x32_bf16 v[40:43], a[164:167], v[212:215], 0
    s_mov_b32 m0, s31
    v_mfma_f32_16x16x32_bf16 v[88:91], a[164:167], v[216:219], 0
    buffer_load_dwordx4 v254, s[20:23], s32 offen offset:0 nt lds
    v_mfma_f32_16x16x32_bf16 v[136:139], a[164:167], v[220:223], 0
    s_add_u32 s25, s25, 12288
    v_mfma_f32_16x16x32_bf16 v[184:187], a[164:167], v[224:227], 0
    buffer_load_dwordx4 v254, s[20:23], s32 offen offset:3072 nt lds
    v_mfma_f32_16x16x32_bf16 a[200:203], a[164:167], v[228:231], 0
    s_sub_u32 s27, 0, s27
    v_mfma_f32_16x16x32_bf16 a[248:251], a[164:167], v[232:235], 0
    s_cmp_lg_u32 s33, 0
    ds_read_b128 a[164:167], v252 offset:2048
    s_mov_b32 s32, 0
    s_mov_b32 s31, s40
    s_mov_b32 s29, 0
    s_mov_b32 s30, 0
    s_mov_b32 s33, 14
.p2align 6
L_loop1:
    s_waitcnt lgkmcnt(1)
    v_mfma_f32_16x16x32_bf16 v[212:215], a[144:147], a[0:3], 0
    s_add_u32 s32, s32, s29
    v_mfma_f32_16x16x32_bf16 v[212:215], a[148:151], a[8:11], v[212:215]
    s_add_u32 s31, s31, s30
    v_mfma_f32_16x16x32_bf16 v[212:215], a[152:155], a[16:19], v[212:215]
    s_min_u32 s31, s31, s37
    v_mfma_f32_16x16x32_bf16 v[212:215], a[156:159], a[4:7], v[212:215]
    v_mfma_f32_16x16x32_bf16 v[212:215], a[160:163], a[12:15], v[212:215]
    s_waitcnt lgkmcnt(0)
    v_mfma_f32_16x16x32_bf16 v[212:215], a[164:167], a[20:23], v[212:215]
    s_cmp_eq_u32 s31, s41
    v_mfma_f32_16x16x32_bf16 v[216:219], a[144:147], a[24:27], 0
    s_cselect_b32 s31, s36, s31
    v_mfma_f32_16x16x32_bf16 v[216:219], a[148:151], a[32:35], v[216:219]
    v_exp_f32 v212, v212
    v_mfma_f32_16x16x32_bf16 v[216:219], a[152:155], a[40:43], v[216:219]
    s_add_u32 s28, s28, 1
    v_exp_f32 v213, v213
    v_mfma_f32_16x16x32_bf16 v[216:219], a[156:159], a[28:31], v[216:219]
    s_cmp_eq_u32 s28, 3
    v_add_f32 v204, v204, v212
    v_add_f32 v204, v204, v213
    v_mfma_f32_16x16x32_bf16 v[216:219], a[160:163], a[36:39], v[216:219]
    s_cselect_b32 s28, 0, s28
    v_exp_f32 v214, v214
    v_mfma_f32_16x16x32_bf16 v[216:219], a[164:167], a[44:47], v[216:219]
    s_cselect_b32 s29, s38, 128
    v_add_f32 v204, v204, v214
    v_cvt_pk_bf16_f32 v212, v212, v213
    v_mfma_f32_16x16x32_bf16 v[220:223], a[144:147], a[48:51], 0
    s_cselect_b32 s30, s39, 1024
    v_exp_f32 v215, v215
    v_mfma_f32_16x16x32_bf16 v[220:223], a[148:151], a[56:59], v[220:223]
    v_add_f32 v204, v204, v215
    v_cvt_pk_bf16_f32 v213, v214, v215
    v_mfma_f32_16x16x32_bf16 v[220:223], a[152:155], a[64:67], v[220:223]
    v_exp_f32 v216, v216
    v_mfma_f32_16x16x32_bf16 v[220:223], a[156:159], a[52:55], v[220:223]
    v_exp_f32 v217, v217
    v_mfma_f32_16x16x32_bf16 v[220:223], a[160:163], a[60:63], v[220:223]
    v_add_f32 v205, v205, v216
    v_add_f32 v205, v205, v217
    v_mfma_f32_16x16x32_bf16 v[220:223], a[164:167], a[68:71], v[220:223]
    v_exp_f32 v218, v218
    v_mfma_f32_16x16x32_bf16 v[224:227], a[144:147], a[72:75], 0
    v_add_f32 v205, v205, v218
    v_cvt_pk_bf16_f32 v216, v216, v217
    v_mfma_f32_16x16x32_bf16 v[224:227], a[148:151], a[80:83], v[224:227]
    v_exp_f32 v219, v219
    v_mfma_f32_16x16x32_bf16 v[224:227], a[152:155], a[88:91], v[224:227]
    v_add_f32 v205, v205, v219
    v_cvt_pk_bf16_f32 v217, v218, v219
    v_mfma_f32_16x16x32_bf16 v[224:227], a[156:159], a[76:79], v[224:227]
    v_exp_f32 v220, v220
    v_mfma_f32_16x16x32_bf16 v[224:227], a[160:163], a[84:87], v[224:227]
    v_exp_f32 v221, v221
    v_mfma_f32_16x16x32_bf16 v[224:227], a[164:167], a[92:95], v[224:227]
    v_add_f32 v206, v206, v220
    v_add_f32 v206, v206, v221
    v_mfma_f32_16x16x32_bf16 v[228:231], a[144:147], a[96:99], 0
    v_exp_f32 v222, v222
    v_mfma_f32_16x16x32_bf16 v[228:231], a[148:151], a[104:107], v[228:231]
    v_add_f32 v206, v206, v222
    v_cvt_pk_bf16_f32 v220, v220, v221
    v_mfma_f32_16x16x32_bf16 v[228:231], a[152:155], a[112:115], v[228:231]
    v_exp_f32 v223, v223
    v_mfma_f32_16x16x32_bf16 v[228:231], a[156:159], a[100:103], v[228:231]
    v_exp_f32 v224, v224
    v_mfma_f32_16x16x32_bf16 v[228:231], a[160:163], a[108:111], v[228:231]
    v_exp_f32 v225, v225
    v_mfma_f32_16x16x32_bf16 v[228:231], a[164:167], a[116:119], v[228:231]
    v_exp_f32 v226, v226
    v_mfma_f32_16x16x32_bf16 v[232:235], a[144:147], a[120:123], 0
    ds_read_b128 a[144:147], v252 offset:6144
    v_add_f32 v206, v206, v223
    v_mfma_f32_16x16x32_bf16 v[232:235], a[148:151], a[128:131], v[232:235]
    ds_read_b128 a[148:151], v252 offset:7168
    v_cvt_pk_bf16_f32 v221, v222, v223
    v_mfma_f32_16x16x32_bf16 v[232:235], a[152:155], a[136:139], v[232:235]
    ds_read_b128 a[152:155], v252 offset:8192
    v_xor_b32 v252, 64, v252
    v_mfma_f32_16x16x32_bf16 v[232:235], a[156:159], a[124:127], v[232:235]
    ds_read_b128 a[156:159], v252 offset:6144
    v_add_f32 v207, v207, v224
    v_mfma_f32_16x16x32_bf16 v[232:235], a[160:163], a[132:135], v[232:235]
    ds_read_b128 a[160:163], v252 offset:7168
    v_add_f32 v207, v207, v225
    v_mfma_f32_16x16x32_bf16 v[232:235], a[164:167], a[140:143], v[232:235]
    s_waitcnt lgkmcnt(4)
    ds_read_b128 a[164:167], v252 offset:8192
    v_cvt_pk_bf16_f32 v224, v224, v225
    v_mfma_f32_16x16x32_bf16 v[236:239], a[144:147], a[4:7], 0
    s_waitcnt lgkmcnt(4)
    v_exp_f32 v227, v227
    v_mfma_f32_16x16x32_bf16 v[236:239], a[148:151], a[12:15], v[236:239]
    s_waitcnt lgkmcnt(3)
    v_add_f32 v207, v207, v226
    v_add_f32 v207, v207, v227
    v_mfma_f32_16x16x32_bf16 v[236:239], a[152:155], a[20:23], v[236:239]
    s_waitcnt lgkmcnt(2)
    v_exp_f32 v228, v228
    v_mfma_f32_16x16x32_bf16 v[236:239], a[156:159], a[0:3], v[236:239]
    s_waitcnt lgkmcnt(1)
    v_add_f32 v208, v208, v228
    v_cvt_pk_bf16_f32 v225, v226, v227
    v_mfma_f32_16x16x32_bf16 v[236:239], a[160:163], a[8:11], v[236:239]
    s_waitcnt lgkmcnt(0)
    v_exp_f32 v229, v229
    v_mfma_f32_16x16x32_bf16 v[236:239], a[164:167], a[16:19], v[236:239]
    v_add_f32 v208, v208, v229
    v_cvt_pk_bf16_f32 v228, v228, v229
    v_mfma_f32_16x16x32_bf16 v[240:243], a[144:147], a[28:31], 0
    v_exp_f32 v230, v230
    v_mfma_f32_16x16x32_bf16 v[240:243], a[148:151], a[36:39], v[240:243]
    v_exp_f32 v231, v231
    v_mfma_f32_16x16x32_bf16 v[240:243], a[152:155], a[44:47], v[240:243]
    v_add_f32 v208, v208, v230
    v_add_f32 v208, v208, v231
    v_mfma_f32_16x16x32_bf16 v[240:243], a[156:159], a[24:27], v[240:243]
    v_exp_f32 v232, v232
    v_mfma_f32_16x16x32_bf16 v[240:243], a[160:163], a[32:35], v[240:243]
    v_add_f32 v209, v209, v232
    v_cvt_pk_bf16_f32 v229, v230, v231
    v_mfma_f32_16x16x32_bf16 v[240:243], a[164:167], a[40:43], v[240:243]
    v_exp_f32 v233, v233
    v_mfma_f32_16x16x32_bf16 v[244:247], a[144:147], a[52:55], 0
    v_add_f32 v209, v209, v233
    v_cvt_pk_bf16_f32 v232, v232, v233
    v_mfma_f32_16x16x32_bf16 v[244:247], a[148:151], a[60:63], v[244:247]
    v_exp_f32 v234, v234
    v_mfma_f32_16x16x32_bf16 v[244:247], a[152:155], a[68:71], v[244:247]
    v_exp_f32 v235, v235
    v_mfma_f32_16x16x32_bf16 v[244:247], a[156:159], a[48:51], v[244:247]
    v_add_f32 v209, v209, v234
    v_add_f32 v209, v209, v235
    v_mfma_f32_16x16x32_bf16 v[244:247], a[160:163], a[56:59], v[244:247]
    v_exp_f32 v236, v236
    v_mfma_f32_16x16x32_bf16 v[244:247], a[164:167], a[64:67], v[244:247]
    v_add_f32 v204, v204, v236
    v_cvt_pk_bf16_f32 v233, v234, v235
    v_mfma_f32_16x16x32_bf16 v[248:251], a[144:147], a[76:79], 0
    v_exp_f32 v237, v237
    v_mfma_f32_16x16x32_bf16 v[248:251], a[148:151], a[84:87], v[248:251]
    v_add_f32 v204, v204, v237
    v_cvt_pk_bf16_f32 v214, v236, v237
    v_mfma_f32_16x16x32_bf16 v[248:251], a[152:155], a[92:95], v[248:251]
    v_exp_f32 v238, v238
    v_mfma_f32_16x16x32_bf16 v[248:251], a[156:159], a[72:75], v[248:251]
    v_exp_f32 v239, v239
    v_mfma_f32_16x16x32_bf16 v[248:251], a[160:163], a[80:83], v[248:251]
    v_add_f32 v204, v204, v238
    v_cvt_pk_bf16_f32 v215, v238, v239
    v_mfma_f32_16x16x32_bf16 v[248:251], a[164:167], a[88:91], v[248:251]
    v_add_f32 v204, v204, v239
    v_exp_f32 v240, v240
    v_mfma_f32_16x16x32_bf16 v[236:239], a[144:147], a[100:103], 0
    v_exp_f32 v241, v241
    v_mfma_f32_16x16x32_bf16 v[236:239], a[148:151], a[108:111], v[236:239]
    v_add_f32 v205, v205, v240
    v_cvt_pk_bf16_f32 v218, v240, v241
    v_mfma_f32_16x16x32_bf16 v[236:239], a[152:155], a[116:119], v[236:239]
    v_exp_f32 v242, v242
    v_mfma_f32_16x16x32_bf16 v[236:239], a[156:159], a[96:99], v[236:239]
    v_add_f32 v205, v205, v241
    v_add_f32 v205, v205, v242
    v_mfma_f32_16x16x32_bf16 v[236:239], a[160:163], a[104:107], v[236:239]
    v_exp_f32 v243, v243
    v_mfma_f32_16x16x32_bf16 v[236:239], a[164:167], a[112:115], v[236:239]
    v_add_f32 v205, v205, v243
    v_cvt_pk_bf16_f32 v219, v242, v243
    v_mfma_f32_16x16x32_bf16 v[240:243], a[144:147], a[124:127], 0
    ds_read_b64_tr_b16 a[144:145], v253 offset:0
    v_mfma_f32_16x16x32_bf16 v[240:243], a[148:151], a[132:135], v[240:243]
    ds_read_b64_tr_b16 a[146:147], v253 offset:6144
    v_mfma_f32_16x16x32_bf16 v[240:243], a[152:155], a[140:143], v[240:243]
    ds_read_b64_tr_b16 a[148:149], v253 offset:1024
    v_mfma_f32_16x16x32_bf16 v[240:243], a[156:159], a[120:123], v[240:243]
    ds_read_b64_tr_b16 a[150:151], v253 offset:7168
    v_mfma_f32_16x16x32_bf16 v[240:243], a[160:163], a[128:131], v[240:243]
    ds_read_b64_tr_b16 a[152:153], v253 offset:2048
    v_mfma_f32_16x16x32_bf16 v[240:243], a[164:167], a[136:139], v[240:243]
    s_waitcnt lgkmcnt(3)
    ds_read_b64_tr_b16 a[154:155], v253 offset:8192
    v_xor_b32 v253, 32, v253
    v_mfma_f32_16x16x32_bf16 v[0:3], a[144:147], v[212:215], v[0:3]
    ds_read_b64_tr_b16 a[156:157], v253 offset:0
    v_mfma_f32_16x16x32_bf16 v[48:51], a[144:147], v[216:219], v[48:51]
    s_waitcnt lgkmcnt(3)
    ds_read_b64_tr_b16 a[158:159], v253 offset:6144
    v_mfma_f32_16x16x32_bf16 v[16:19], a[148:151], v[212:215], v[16:19]
    ds_read_b64_tr_b16 a[160:161], v253 offset:1024
    v_mfma_f32_16x16x32_bf16 v[64:67], a[148:151], v[216:219], v[64:67]
    s_waitcnt lgkmcnt(3)
    ds_read_b64_tr_b16 a[162:163], v253 offset:7168
    v_mfma_f32_16x16x32_bf16 v[32:35], a[152:155], v[212:215], v[32:35]
    ds_read_b64_tr_b16 a[164:165], v253 offset:2048
    v_mfma_f32_16x16x32_bf16 v[80:83], a[152:155], v[216:219], v[80:83]
    s_waitcnt lgkmcnt(3)
    ds_read_b64_tr_b16 a[166:167], v253 offset:8192
    v_xor_b32 v253, 64, v253
    v_mfma_f32_16x16x32_bf16 v[4:7], a[156:159], v[212:215], v[4:7]
    v_exp_f32 v244, v244
    v_mfma_f32_16x16x32_bf16 v[52:55], a[156:159], v[216:219], v[52:55]
    s_waitcnt lgkmcnt(2)
    v_exp_f32 v245, v245
    v_mfma_f32_16x16x32_bf16 v[20:23], a[160:163], v[212:215], v[20:23]
    v_exp_f32 v246, v246
    v_mfma_f32_16x16x32_bf16 v[68:71], a[160:163], v[216:219], v[68:71]
    s_waitcnt lgkmcnt(0)
    v_exp_f32 v247, v247
    v_mfma_f32_16x16x32_bf16 v[36:39], a[164:167], v[212:215], v[36:39]
    v_cvt_pk_bf16_f32 v222, v244, v245
    v_cvt_pk_bf16_f32 v223, v246, v247
    v_mfma_f32_16x16x32_bf16 v[84:87], a[164:167], v[216:219], v[84:87]
    v_add_f32 v206, v206, v244
    v_add_f32 v206, v206, v245
    v_mfma_f32_16x16x32_bf16 v[96:99], a[144:147], v[220:223], v[96:99]
    v_exp_f32 v248, v248
    v_mfma_f32_16x16x32_bf16 v[112:115], a[148:151], v[220:223], v[112:115]
    v_exp_f32 v249, v249
    v_mfma_f32_16x16x32_bf16 v[128:131], a[152:155], v[220:223], v[128:131]
    v_exp_f32 v250, v250
    v_mfma_f32_16x16x32_bf16 v[100:103], a[156:159], v[220:223], v[100:103]
    v_exp_f32 v251, v251
    v_mfma_f32_16x16x32_bf16 v[116:119], a[160:163], v[220:223], v[116:119]
    v_cvt_pk_bf16_f32 v226, v248, v249
    v_cvt_pk_bf16_f32 v227, v250, v251
    v_mfma_f32_16x16x32_bf16 v[132:135], a[164:167], v[220:223], v[132:135]
    v_add_f32 v206, v206, v246
    v_add_f32 v206, v206, v247
    v_mfma_f32_16x16x32_bf16 v[144:147], a[144:147], v[224:227], v[144:147]
    v_exp_f32 v236, v236
    v_mfma_f32_16x16x32_bf16 v[160:163], a[148:151], v[224:227], v[160:163]
    v_exp_f32 v237, v237
    v_mfma_f32_16x16x32_bf16 v[176:179], a[152:155], v[224:227], v[176:179]
    v_exp_f32 v238, v238
    v_mfma_f32_16x16x32_bf16 v[148:151], a[156:159], v[224:227], v[148:151]
    v_exp_f32 v239, v239
    v_mfma_f32_16x16x32_bf16 v[164:167], a[160:163], v[224:227], v[164:167]
    v_cvt_pk_bf16_f32 v230, v236, v237
    v_cvt_pk_bf16_f32 v231, v238, v239
    v_mfma_f32_16x16x32_bf16 v[180:183], a[164:167], v[224:227], v[180:183]
    v_add_f32 v207, v207, v248
    v_add_f32 v207, v207, v249
    v_mfma_f32_16x16x32_bf16 v[192:195], a[144:147], v[228:231], v[192:195]
    v_exp_f32 v240, v240
    v_mfma_f32_16x16x32_bf16 a[172:175], a[148:151], v[228:231], a[172:175]
    v_exp_f32 v241, v241
    v_mfma_f32_16x16x32_bf16 a[192:195], a[152:155], v[228:231], a[192:195]
    v_exp_f32 v242, v242
    v_mfma_f32_16x16x32_bf16 v[196:199], a[156:159], v[228:231], v[196:199]
    v_exp_f32 v243, v243
    v_mfma_f32_16x16x32_bf16 a[180:183], a[160:163], v[228:231], a[180:183]
    v_cvt_pk_bf16_f32 v234, v240, v241
    v_cvt_pk_bf16_f32 v235, v242, v243
    v_mfma_f32_16x16x32_bf16 a[196:199], a[164:167], v[228:231], a[196:199]
    v_add_f32 v207, v207, v250
    v_add_f32 v207, v207, v251
    v_mfma_f32_16x16x32_bf16 a[208:211], a[144:147], v[232:235], a[208:211]
    ds_read_b64_tr_b16 a[144:145], v253 offset:0
    v_add_f32 v208, v208, v236
    v_mfma_f32_16x16x32_bf16 a[224:227], a[148:151], v[232:235], a[224:227]
    ds_read_b64_tr_b16 a[146:147], v253 offset:6144
    v_add_f32 v208, v208, v237
    v_mfma_f32_16x16x32_bf16 a[240:243], a[152:155], v[232:235], a[240:243]
    ds_read_b64_tr_b16 a[148:149], v253 offset:1024
    v_add_f32 v208, v208, v238
    v_mfma_f32_16x16x32_bf16 a[212:215], a[156:159], v[232:235], a[212:215]
    ds_read_b64_tr_b16 a[150:151], v253 offset:7168
    v_add_f32 v208, v208, v239
    v_mfma_f32_16x16x32_bf16 a[228:231], a[160:163], v[232:235], a[228:231]
    ds_read_b64_tr_b16 a[152:153], v253 offset:2048
    v_add_f32 v209, v209, v240
    v_mfma_f32_16x16x32_bf16 a[244:247], a[164:167], v[232:235], a[244:247]
    s_waitcnt lgkmcnt(3)
    ds_read_b64_tr_b16 a[154:155], v253 offset:8192
    v_xor_b32 v253, 32, v253
    v_mfma_f32_16x16x32_bf16 v[12:15], a[144:147], v[212:215], v[12:15]
    ds_read_b64_tr_b16 a[156:157], v253 offset:0
    v_add_f32 v209, v209, v241
    v_mfma_f32_16x16x32_bf16 v[60:63], a[144:147], v[216:219], v[60:63]
    ds_read_b64_tr_b16 a[158:159], v253 offset:6144
    v_add_f32 v209, v209, v242
    v_mfma_f32_16x16x32_bf16 v[108:111], a[144:147], v[220:223], v[108:111]
    ds_read_b64_tr_b16 a[160:161], v253 offset:1024
    v_add_f32 v209, v209, v243
    v_mfma_f32_16x16x32_bf16 v[156:159], a[144:147], v[224:227], v[156:159]
    ds_read_b64_tr_b16 a[162:163], v253 offset:7168
    v_mfma_f32_16x16x32_bf16 a[168:171], a[144:147], v[228:231], a[168:171]
    ds_read_b64_tr_b16 a[164:165], v253 offset:2048
    v_add_u32 v252, s27, v252
    v_mfma_f32_16x16x32_bf16 a[220:223], a[144:147], v[232:235], a[220:223]
    s_waitcnt lgkmcnt(7)
    ds_read_b64_tr_b16 a[166:167], v253 offset:8192
    v_xad_u32 v253, v253, 64, s27
    v_mfma_f32_16x16x32_bf16 v[28:31], a[148:151], v[212:215], v[28:31]
    v_mfma_f32_16x16x32_bf16 v[76:79], a[148:151], v[216:219], v[76:79]
    v_mfma_f32_16x16x32_bf16 v[124:127], a[148:151], v[220:223], v[124:127]
    v_mfma_f32_16x16x32_bf16 v[172:175], a[148:151], v[224:227], v[172:175]
    s_waitcnt vmcnt(2) lgkmcnt(0)
    v_mfma_f32_16x16x32_bf16 a[188:191], a[148:151], v[228:231], a[188:191]
    s_barrier
    v_mfma_f32_16x16x32_bf16 a[236:239], a[148:151], v[232:235], a[236:239]
    ds_read_b128 a[144:147], v252 offset:0
    v_mfma_f32_16x16x32_bf16 v[44:47], a[152:155], v[212:215], v[44:47]
    ds_read_b128 a[148:151], v252 offset:1024
    v_mfma_f32_16x16x32_bf16 v[92:95], a[152:155], v[216:219], v[92:95]
    s_mov_b32 m0, s26
    v_mfma_f32_16x16x32_bf16 v[140:143], a[152:155], v[220:223], v[140:143]
    buffer_load_dwordx4 v254, s[8:11], s25 offen offset:0 nt lds
    v_mfma_f32_16x16x32_bf16 v[188:191], a[152:155], v[224:227], v[188:191]
    s_add_u32 m0, s26, 896
    v_mfma_f32_16x16x32_bf16 a[204:207], a[152:155], v[228:231], a[204:207]
    buffer_load_dwordx4 v254, s[8:11], s25 offen offset:128 nt lds
    v_mfma_f32_16x16x32_bf16 a[252:255], a[152:155], v[232:235], a[252:255]
    ds_read_b128 a[152:155], v252 offset:2048
    v_xor_b32 v252, 64, v252
    v_mfma_f32_16x16x32_bf16 v[8:11], a[156:159], v[212:215], v[8:11]
    s_add_u32 m0, s26, 1792
    v_mfma_f32_16x16x32_bf16 v[56:59], a[156:159], v[216:219], v[56:59]
    buffer_load_dwordx4 v254, s[8:11], s25 offen offset:256 nt lds
    v_mfma_f32_16x16x32_bf16 v[104:107], a[156:159], v[220:223], v[104:107]
    s_add_u32 m0, s26, 36864
    v_mfma_f32_16x16x32_bf16 v[152:155], a[156:159], v[224:227], v[152:155]
    buffer_load_dwordx4 v254, s[12:15], s25 offen offset:0 nt lds
    v_mfma_f32_16x16x32_bf16 v[200:203], a[156:159], v[228:231], v[200:203]
    s_sub_u32 s33, s33, 1
    v_mfma_f32_16x16x32_bf16 a[216:219], a[156:159], v[232:235], a[216:219]
    ds_read_b128 a[156:159], v252 offset:0
    v_mfma_f32_16x16x32_bf16 v[24:27], a[160:163], v[212:215], v[24:27]
    s_add_u32 m0, s26, 37760
    v_mfma_f32_16x16x32_bf16 v[72:75], a[160:163], v[216:219], v[72:75]
    buffer_load_dwordx4 v254, s[12:15], s25 offen offset:128 nt lds
    v_mfma_f32_16x16x32_bf16 v[120:123], a[160:163], v[220:223], v[120:123]
    s_add_u32 m0, s26, 38656
    v_mfma_f32_16x16x32_bf16 v[168:171], a[160:163], v[224:227], v[168:171]
    buffer_load_dwordx4 v254, s[12:15], s25 offen offset:256 nt lds
    v_mfma_f32_16x16x32_bf16 a[184:187], a[160:163], v[228:231], a[184:187]
    s_add_u32 s26, s26, s27
    v_mfma_f32_16x16x32_bf16 a[232:235], a[160:163], v[232:235], a[232:235]
    ds_read_b128 a[160:163], v252 offset:1024
    v_mfma_f32_16x16x32_bf16 v[40:43], a[164:167], v[212:215], v[40:43]
    s_mov_b32 m0, s31
    v_mfma_f32_16x16x32_bf16 v[88:91], a[164:167], v[216:219], v[88:91]
    buffer_load_dwordx4 v254, s[20:23], s32 offen offset:0 nt lds
    v_mfma_f32_16x16x32_bf16 v[136:139], a[164:167], v[220:223], v[136:139]
    s_add_u32 s25, s25, 12288
    v_mfma_f32_16x16x32_bf16 v[184:187], a[164:167], v[224:227], v[184:187]
    buffer_load_dwordx4 v254, s[20:23], s32 offen offset:3072 nt lds
    v_mfma_f32_16x16x32_bf16 a[200:203], a[164:167], v[228:231], a[200:203]
    s_sub_u32 s27, 0, s27
    v_mfma_f32_16x16x32_bf16 a[248:251], a[164:167], v[232:235], a[248:251]
    s_cmp_lg_u32 s33, 0
    ds_read_b128 a[164:167], v252 offset:2048
    s_cbranch_scc1 L_loop1
    s_mov_b32 s22, 36864
    s_waitcnt lgkmcnt(1)
    v_mfma_f32_16x16x32_bf16 v[212:215], a[144:147], a[0:3], 0
    v_mfma_f32_16x16x32_bf16 v[212:215], a[148:151], a[8:11], v[212:215]
    v_mfma_f32_16x16x32_bf16 v[212:215], a[152:155], a[16:19], v[212:215]
    v_mfma_f32_16x16x32_bf16 v[212:215], a[156:159], a[4:7], v[212:215]
    v_mfma_f32_16x16x32_bf16 v[212:215], a[160:163], a[12:15], v[212:215]
    s_waitcnt lgkmcnt(0)
    v_mfma_f32_16x16x32_bf16 v[212:215], a[164:167], a[20:23], v[212:215]
    v_mfma_f32_16x16x32_bf16 v[216:219], a[144:147], a[24:27], 0
    v_mfma_f32_16x16x32_bf16 v[216:219], a[148:151], a[32:35], v[216:219]
    v_exp_f32 v212, v212
    v_mfma_f32_16x16x32_bf16 v[216:219], a[152:155], a[40:43], v[216:219]
    v_exp_f32 v213, v213
    v_mfma_f32_16x16x32_bf16 v[216:219], a[156:159], a[28:31], v[216:219]
    v_add_f32 v204, v204, v212
    v_add_f32 v204, v204, v213
    v_mfma_f32_16x16x32_bf16 v[216:219], a[160:163], a[36:39], v[216:219]
    v_exp_f32 v214, v214
    v_mfma_f32_16x16x32_bf16 v[216:219], a[164:167], a[44:47], v[216:219]
    v_add_f32 v204, v204, v214
    v_cvt_pk_bf16_f32 v212, v212, v213
    v_mfma_f32_16x16x32_bf16 v[220:223], a[144:147], a[48:51], 0
    v_exp_f32 v215, v215
    v_mfma_f32_16x16x32_bf16 v[220:223], a[148:151], a[56:59], v[220:223]
    v_add_f32 v204, v204, v215
    v_cvt_pk_bf16_f32 v213, v214, v215
    v_mfma_f32_16x16x32_bf16 v[220:223], a[152:155], a[64:67], v[220:223]
    v_exp_f32 v216, v216
    v_mfma_f32_16x16x32_bf16 v[220:223], a[156:159], a[52:55], v[220:223]
    v_exp_f32 v217, v217
    v_mfma_f32_16x16x32_bf16 v[220:223], a[160:163], a[60:63], v[220:223]
    v_add_f32 v205, v205, v216
    v_add_f32 v205, v205, v217
    v_mfma_f32_16x16x32_bf16 v[220:223], a[164:167], a[68:71], v[220:223]
    v_exp_f32 v218, v218
    v_mfma_f32_16x16x32_bf16 v[224:227], a[144:147], a[72:75], 0
    v_add_f32 v205, v205, v218
    v_cvt_pk_bf16_f32 v216, v216, v217
    v_mfma_f32_16x16x32_bf16 v[224:227], a[148:151], a[80:83], v[224:227]
    v_exp_f32 v219, v219
    v_mfma_f32_16x16x32_bf16 v[224:227], a[152:155], a[88:91], v[224:227]
    v_add_f32 v205, v205, v219
    v_cvt_pk_bf16_f32 v217, v218, v219
    v_mfma_f32_16x16x32_bf16 v[224:227], a[156:159], a[76:79], v[224:227]
    v_exp_f32 v220, v220
    v_mfma_f32_16x16x32_bf16 v[224:227], a[160:163], a[84:87], v[224:227]
    v_exp_f32 v221, v221
    v_mfma_f32_16x16x32_bf16 v[224:227], a[164:167], a[92:95], v[224:227]
    v_add_f32 v206, v206, v220
    v_add_f32 v206, v206, v221
    v_mfma_f32_16x16x32_bf16 v[228:231], a[144:147], a[96:99], 0
    v_exp_f32 v222, v222
    v_mfma_f32_16x16x32_bf16 v[228:231], a[148:151], a[104:107], v[228:231]
    v_exp_f32 v223, v223
    v_mfma_f32_16x16x32_bf16 v[228:231], a[152:155], a[112:115], v[228:231]
    v_exp_f32 v224, v224
    v_mfma_f32_16x16x32_bf16 v[228:231], a[156:159], a[100:103], v[228:231]
    v_exp_f32 v225, v225
    v_mfma_f32_16x16x32_bf16 v[228:231], a[160:163], a[108:111], v[228:231]
    v_exp_f32 v226, v226
    v_mfma_f32_16x16x32_bf16 v[228:231], a[164:167], a[116:119], v[228:231]
    v_exp_f32 v227, v227
    v_mfma_f32_16x16x32_bf16 v[232:235], a[144:147], a[120:123], 0
    ds_read_b128 a[144:147], v252 offset:6144
    v_cvt_pk_bf16_f32 v220, v220, v221
    v_mfma_f32_16x16x32_bf16 v[232:235], a[148:151], a[128:131], v[232:235]
    ds_read_b128 a[148:151], v252 offset:7168
    v_add_f32 v206, v206, v222
    v_mfma_f32_16x16x32_bf16 v[232:235], a[152:155], a[136:139], v[232:235]
    ds_read_b128 a[152:155], v252 offset:8192
    v_xor_b32 v252, 64, v252
    v_mfma_f32_16x16x32_bf16 v[232:235], a[156:159], a[124:127], v[232:235]
    ds_read_b128 a[156:159], v252 offset:6144
    v_add_f32 v206, v206, v223
    v_mfma_f32_16x16x32_bf16 v[232:235], a[160:163], a[132:135], v[232:235]
    ds_read_b128 a[160:163], v252 offset:7168
    v_cvt_pk_bf16_f32 v221, v222, v223
    v_mfma_f32_16x16x32_bf16 v[232:235], a[164:167], a[140:143], v[232:235]
    s_waitcnt lgkmcnt(4)
    ds_read_b128 a[164:167], v252 offset:8192
    v_add_f32 v207, v207, v224
    v_mfma_f32_16x16x32_bf16 v[236:239], a[144:147], a[4:7], 0
    s_waitcnt lgkmcnt(4)
    s_sub_u32 s44, s40, 12288
    v_add_u32 v255, s44, v252
    s_sub_u32 s44, s36, s40
    v_mfma_f32_16x16x32_bf16 v[236:239], a[148:151], a[12:15], v[236:239]
    s_waitcnt lgkmcnt(3)
    v_exp_f32 v228, v228
    v_mfma_f32_16x16x32_bf16 v[236:239], a[152:155], a[20:23], v[236:239]
    s_waitcnt lgkmcnt(2)
    v_exp_f32 v229, v229
    v_mfma_f32_16x16x32_bf16 v[236:239], a[156:159], a[0:3], v[236:239]
    s_waitcnt lgkmcnt(1)
    v_exp_f32 v230, v230
    v_mfma_f32_16x16x32_bf16 v[236:239], a[160:163], a[8:11], v[236:239]
    s_waitcnt lgkmcnt(0)
    v_exp_f32 v231, v231
    v_mfma_f32_16x16x32_bf16 v[236:239], a[164:167], a[16:19], v[236:239]
    v_exp_f32 v232, v232
    v_mfma_f32_16x16x32_bf16 v[240:243], a[144:147], a[28:31], 0
    ds_read_b128 a[0:3], v255 offset:0
    v_add_f32 v207, v207, v225
    v_mfma_f32_16x16x32_bf16 v[240:243], a[148:151], a[36:39], v[240:243]
    ds_read_b128 a[8:11], v255 offset:1024
    v_cvt_pk_bf16_f32 v224, v224, v225
    v_mfma_f32_16x16x32_bf16 v[240:243], a[152:155], a[44:47], v[240:243]
    ds_read_b128 a[16:19], v255 offset:2048
    v_xor_b32 v255, 64, v255
    v_mfma_f32_16x16x32_bf16 v[240:243], a[156:159], a[24:27], v[240:243]
    ds_read_b128 a[4:7], v255 offset:0
    v_add_f32 v207, v207, v226
    v_mfma_f32_16x16x32_bf16 v[240:243], a[160:163], a[32:35], v[240:243]
    ds_read_b128 a[12:15], v255 offset:1024
    v_add_f32 v207, v207, v227
    v_mfma_f32_16x16x32_bf16 v[240:243], a[164:167], a[40:43], v[240:243]
    ds_read_b128 a[20:23], v255 offset:2048
    v_add_u32 v255, s44, v255
    v_mfma_f32_16x16x32_bf16 v[244:247], a[144:147], a[52:55], 0
    ds_read_b128 a[28:31], v255 offset:0
    v_cvt_pk_bf16_f32 v225, v226, v227
    v_mfma_f32_16x16x32_bf16 v[244:247], a[148:151], a[60:63], v[244:247]
    ds_read_b128 a[36:39], v255 offset:1024
    v_add_f32 v208, v208, v228
    v_mfma_f32_16x16x32_bf16 v[244:247], a[152:155], a[68:71], v[244:247]
    ds_read_b128 a[44:47], v255 offset:2048
    v_xor_b32 v255, 64, v255
    v_mfma_f32_16x16x32_bf16 v[244:247], a[156:159], a[48:51], v[244:247]
    ds_read_b128 a[24:27], v255 offset:0
    v_add_f32 v208, v208, v229
    v_mfma_f32_16x16x32_bf16 v[244:247], a[160:163], a[56:59], v[244:247]
    ds_read_b128 a[32:35], v255 offset:1024
    v_cvt_pk_bf16_f32 v228, v228, v229
    v_mfma_f32_16x16x32_bf16 v[244:247], a[164:167], a[64:67], v[244:247]
    ds_read_b128 a[40:43], v255 offset:2048
    v_add_f32 v208, v208, v230
    v_mfma_f32_16x16x32_bf16 v[248:251], a[144:147], a[76:79], 0
    ds_read_b128 a[48:51], v255 offset:6144
    v_add_f32 v208, v208, v231
    v_exp_f32 v233, v233
    v_mfma_f32_16x16x32_bf16 v[248:251], a[148:151], a[84:87], v[248:251]
    ds_read_b128 a[56:59], v255 offset:7168
    v_add_f32 v209, v209, v232
    v_exp_f32 v234, v234
    v_exp_f32 v235, v235
    v_mfma_f32_16x16x32_bf16 v[248:251], a[152:155], a[92:95], v[248:251]
    ds_read_b128 a[64:67], v255 offset:8192
    v_xor_b32 v255, 64, v255
    v_add_f32 v209, v209, v233
    v_add_f32 v209, v209, v234
    v_add_f32 v209, v209, v235
    v_cvt_pk_bf16_f32 v229, v230, v231
    v_cvt_pk_bf16_f32 v232, v232, v233
    v_mfma_f32_16x16x32_bf16 v[248:251], a[156:159], a[72:75], v[248:251]
    s_waitcnt lgkmcnt(3)
    s_add_u32 m0, s36, 0
    s_mov_b32 s44, 24576
    ds_read_b128 a[52:55], v255 offset:6144
    v_cvt_pk_bf16_f32 v233, v234, v235
    v_exp_f32 v236, v236
    v_exp_f32 v237, v237
    v_mfma_f32_16x16x32_bf16 v[248:251], a[160:163], a[80:83], v[248:251]
    ds_read_b128 a[60:63], v255 offset:7168
    buffer_load_dwordx4 v254, s[20:23], s44 offen offset:0 nt lds
    v_add_f32 v204, v204, v236
    v_exp_f32 v238, v238
    v_exp_f32 v239, v239
    v_mfma_f32_16x16x32_bf16 v[248:251], a[164:167], a[88:91], v[248:251]
    s_add_u32 m0, s36, 896
    ds_read_b128 a[68:71], v255 offset:8192
    v_add_f32 v204, v204, v237
    v_add_f32 v204, v204, v238
    v_add_f32 v204, v204, v239
    v_cvt_pk_bf16_f32 v214, v236, v237
    v_cvt_pk_bf16_f32 v215, v238, v239
    v_mfma_f32_16x16x32_bf16 v[236:239], a[144:147], a[100:103], 0
    ds_read_b128 a[76:79], v255 offset:12288
    buffer_load_dwordx4 v254, s[20:23], s44 offen offset:128 nt lds
    v_mfma_f32_16x16x32_bf16 v[236:239], a[148:151], a[108:111], v[236:239]
    s_add_u32 m0, s36, 1792
    ds_read_b128 a[84:87], v255 offset:13312
    v_exp_f32 v240, v240
    v_mfma_f32_16x16x32_bf16 v[236:239], a[152:155], a[116:119], v[236:239]
    ds_read_b128 a[92:95], v255 offset:14336
    buffer_load_dwordx4 v254, s[20:23], s44 offen offset:256 nt lds
    v_xor_b32 v255, 64, v255
    v_mfma_f32_16x16x32_bf16 v[236:239], a[156:159], a[96:99], v[236:239]
    s_add_u32 m0, s36, 3072
    s_mov_b32 s44, 27648
    ds_read_b128 a[72:75], v255 offset:12288
    v_exp_f32 v241, v241
    v_mfma_f32_16x16x32_bf16 v[236:239], a[160:163], a[104:107], v[236:239]
    ds_read_b128 a[80:83], v255 offset:13312
    buffer_load_dwordx4 v254, s[20:23], s44 offen offset:0 nt lds
    v_add_f32 v205, v205, v240
    v_exp_f32 v242, v242
    v_exp_f32 v243, v243
    v_mfma_f32_16x16x32_bf16 v[236:239], a[164:167], a[112:115], v[236:239]
    s_add_u32 m0, s36, 3968
    ds_read_b128 a[88:91], v255 offset:14336
    v_add_f32 v205, v205, v241
    v_add_f32 v205, v205, v242
    v_add_f32 v205, v205, v243
    v_cvt_pk_bf16_f32 v218, v240, v241
    v_cvt_pk_bf16_f32 v219, v242, v243
    v_mfma_f32_16x16x32_bf16 v[240:243], a[144:147], a[124:127], 0
    ds_read_b64_tr_b16 a[144:145], v253 offset:0
    buffer_load_dwordx4 v254, s[20:23], s44 offen offset:128 nt lds
    v_mfma_f32_16x16x32_bf16 v[240:243], a[148:151], a[132:135], v[240:243]
    s_add_u32 m0, s36, 4864
    ds_read_b64_tr_b16 a[146:147], v253 offset:6144
    v_exp_f32 v244, v244
    v_mfma_f32_16x16x32_bf16 v[240:243], a[152:155], a[140:143], v[240:243]
    ds_read_b64_tr_b16 a[148:149], v253 offset:1024
    buffer_load_dwordx4 v254, s[20:23], s44 offen offset:256 nt lds
    v_mfma_f32_16x16x32_bf16 v[240:243], a[156:159], a[120:123], v[240:243]
    s_waitcnt lgkmcnt(9)
    s_add_u32 m0, s36, 6144
    s_mov_b32 s44, 30720
    ds_read_b64_tr_b16 a[150:151], v253 offset:7168
    v_add_f32 v206, v206, v244
    v_mfma_f32_16x16x32_bf16 v[240:243], a[160:163], a[128:131], v[240:243]
    ds_read_b64_tr_b16 a[152:153], v253 offset:2048
    buffer_load_dwordx4 v254, s[20:23], s44 offen offset:0 nt lds
    v_mfma_f32_16x16x32_bf16 v[240:243], a[164:167], a[136:139], v[240:243]
    s_waitcnt lgkmcnt(3)
    s_add_u32 m0, s36, 7040
    ds_read_b64_tr_b16 a[154:155], v253 offset:8192
    v_xor_b32 v253, 32, v253
    v_mfma_f32_16x16x32_bf16 v[0:3], a[144:147], v[212:215], v[0:3]
    ds_read_b64_tr_b16 a[156:157], v253 offset:0
    buffer_load_dwordx4 v254, s[20:23], s44 offen offset:128 nt lds
    v_mfma_f32_16x16x32_bf16 v[48:51], a[144:147], v[216:219], v[48:51]
    s_waitcnt lgkmcnt(3)
    s_add_u32 m0, s36, 7936
    ds_read_b64_tr_b16 a[158:159], v253 offset:6144
    v_exp_f32 v245, v245
    v_mfma_f32_16x16x32_bf16 v[16:19], a[148:151], v[212:215], v[16:19]
    ds_read_b64_tr_b16 a[160:161], v253 offset:1024
    buffer_load_dwordx4 v254, s[20:23], s44 offen offset:256 nt lds
    v_mfma_f32_16x16x32_bf16 v[64:67], a[148:151], v[216:219], v[64:67]
    s_waitcnt lgkmcnt(3)
    s_add_u32 m0, s36, 9216
    s_mov_b32 s44, 33792
    ds_read_b64_tr_b16 a[162:163], v253 offset:7168
    v_cvt_pk_bf16_f32 v222, v244, v245
    v_mfma_f32_16x16x32_bf16 v[32:35], a[152:155], v[212:215], v[32:35]
    ds_read_b64_tr_b16 a[164:165], v253 offset:2048
    buffer_load_dwordx4 v254, s[20:23], s44 offen offset:0 nt lds
    v_mfma_f32_16x16x32_bf16 v[80:83], a[152:155], v[216:219], v[80:83]
    s_waitcnt lgkmcnt(3)
    s_add_u32 m0, s36, 10112
    ds_read_b64_tr_b16 a[166:167], v253 offset:8192
    v_xor_b32 v253, 64, v253
    v_mfma_f32_16x16x32_bf16 v[4:7], a[156:159], v[212:215], v[4:7]
    buffer_load_dwordx4 v254, s[20:23], s44 offen offset:128 nt lds
    v_add_f32 v206, v206, v245
    v_mfma_f32_16x16x32_bf16 v[52:55], a[156:159], v[216:219], v[52:55]
    s_waitcnt lgkmcnt(2)
    s_add_u32 m0, s36, 11008
    v_exp_f32 v246, v246
    v_mfma_f32_16x16x32_bf16 v[20:23], a[160:163], v[212:215], v[20:23]
    buffer_load_dwordx4 v254, s[20:23], s44 offen offset:256 nt lds
    v_add_f32 v206, v206, v246
    v_mfma_f32_16x16x32_bf16 v[68:71], a[160:163], v[216:219], v[68:71]
    s_waitcnt lgkmcnt(0)
    v_exp_f32 v247, v247
    v_mfma_f32_16x16x32_bf16 v[36:39], a[164:167], v[212:215], v[36:39]
    v_add_f32 v206, v206, v247
    v_cvt_pk_bf16_f32 v223, v246, v247
    v_mfma_f32_16x16x32_bf16 v[84:87], a[164:167], v[216:219], v[84:87]
    v_exp_f32 v248, v248
    v_mfma_f32_16x16x32_bf16 v[96:99], a[144:147], v[220:223], v[96:99]
    v_exp_f32 v249, v249
    v_mfma_f32_16x16x32_bf16 v[112:115], a[148:151], v[220:223], v[112:115]
    v_add_f32 v207, v207, v248
    v_cvt_pk_bf16_f32 v226, v248, v249
    v_mfma_f32_16x16x32_bf16 v[128:131], a[152:155], v[220:223], v[128:131]
    v_exp_f32 v250, v250
    v_mfma_f32_16x16x32_bf16 v[100:103], a[156:159], v[220:223], v[100:103]
    v_exp_f32 v251, v251
    v_mfma_f32_16x16x32_bf16 v[116:119], a[160:163], v[220:223], v[116:119]
    v_add_f32 v207, v207, v249
    v_cvt_pk_bf16_f32 v227, v250, v251
    v_mfma_f32_16x16x32_bf16 v[132:135], a[164:167], v[220:223], v[132:135]
    v_add_f32 v207, v207, v250
    v_add_f32 v207, v207, v251
    v_mfma_f32_16x16x32_bf16 v[144:147], a[144:147], v[224:227], v[144:147]
    v_exp_f32 v236, v236
    v_mfma_f32_16x16x32_bf16 v[160:163], a[148:151], v[224:227], v[160:163]
    v_exp_f32 v237, v237
    v_mfma_f32_16x16x32_bf16 v[176:179], a[152:155], v[224:227], v[176:179]
    v_exp_f32 v238, v238
    v_mfma_f32_16x16x32_bf16 v[148:151], a[156:159], v[224:227], v[148:151]
    v_exp_f32 v239, v239
    v_mfma_f32_16x16x32_bf16 v[164:167], a[160:163], v[224:227], v[164:167]
    v_cvt_pk_bf16_f32 v230, v236, v237
    v_cvt_pk_bf16_f32 v231, v238, v239
    v_mfma_f32_16x16x32_bf16 v[180:183], a[164:167], v[224:227], v[180:183]
    v_add_f32 v208, v208, v236
    v_add_f32 v208, v208, v237
    v_mfma_f32_16x16x32_bf16 v[192:195], a[144:147], v[228:231], v[192:195]
    v_exp_f32 v240, v240
    v_mfma_f32_16x16x32_bf16 a[172:175], a[148:151], v[228:231], a[172:175]
    v_exp_f32 v241, v241
    v_mfma_f32_16x16x32_bf16 a[192:195], a[152:155], v[228:231], a[192:195]
    v_exp_f32 v242, v242
    v_mfma_f32_16x16x32_bf16 v[196:199], a[156:159], v[228:231], v[196:199]
    v_exp_f32 v243, v243
    v_mfma_f32_16x16x32_bf16 a[180:183], a[160:163], v[228:231], a[180:183]
    v_cvt_pk_bf16_f32 v234, v240, v241
    v_cvt_pk_bf16_f32 v235, v242, v243
    v_mfma_f32_16x16x32_bf16 a[196:199], a[164:167], v[228:231], a[196:199]
    v_add_f32 v208, v208, v238
    v_add_f32 v208, v208, v239
    v_mfma_f32_16x16x32_bf16 a[208:211], a[144:147], v[232:235], a[208:211]
    ds_read_b64_tr_b16 a[144:145], v253 offset:0
    v_add_f32 v209, v209, v240
    v_mfma_f32_16x16x32_bf16 a[224:227], a[148:151], v[232:235], a[224:227]
    ds_read_b64_tr_b16 a[146:147], v253 offset:6144
    v_add_f32 v209, v209, v241
    v_mfma_f32_16x16x32_bf16 a[240:243], a[152:155], v[232:235], a[240:243]
    ds_read_b64_tr_b16 a[148:149], v253 offset:1024
    v_add_f32 v209, v209, v242
    v_mfma_f32_16x16x32_bf16 a[212:215], a[156:159], v[232:235], a[212:215]
    ds_read_b64_tr_b16 a[150:151], v253 offset:7168
    v_add_f32 v209, v209, v243
    v_mfma_f32_16x16x32_bf16 a[228:231], a[160:163], v[232:235], a[228:231]
    ds_read_b64_tr_b16 a[152:153], v253 offset:2048
    v_mfma_f32_16x16x32_bf16 a[244:247], a[164:167], v[232:235], a[244:247]
    s_waitcnt lgkmcnt(3)
    ds_read_b64_tr_b16 a[154:155], v253 offset:8192
    v_xor_b32 v253, 32, v253
    v_mfma_f32_16x16x32_bf16 v[12:15], a[144:147], v[212:215], v[12:15]
    ds_read_b64_tr_b16 a[156:157], v253 offset:0
    v_mfma_f32_16x16x32_bf16 v[60:63], a[144:147], v[216:219], v[60:63]
    ds_read_b64_tr_b16 a[158:159], v253 offset:6144
    v_mfma_f32_16x16x32_bf16 v[108:111], a[144:147], v[220:223], v[108:111]
    ds_read_b64_tr_b16 a[160:161], v253 offset:1024
    v_mfma_f32_16x16x32_bf16 v[156:159], a[144:147], v[224:227], v[156:159]
    ds_read_b64_tr_b16 a[162:163], v253 offset:7168
    v_mfma_f32_16x16x32_bf16 a[168:171], a[144:147], v[228:231], a[168:171]
    ds_read_b64_tr_b16 a[164:165], v253 offset:2048
    v_add_u32 v252, s27, v252
    v_mfma_f32_16x16x32_bf16 a[220:223], a[144:147], v[232:235], a[220:223]
    s_waitcnt lgkmcnt(7)
    ds_read_b64_tr_b16 a[166:167], v253 offset:8192
    v_xad_u32 v253, v253, 64, s27
    v_mfma_f32_16x16x32_bf16 v[28:31], a[148:151], v[212:215], v[28:31]
    v_mfma_f32_16x16x32_bf16 v[76:79], a[148:151], v[216:219], v[76:79]
    v_mfma_f32_16x16x32_bf16 v[124:127], a[148:151], v[220:223], v[124:127]
    v_mfma_f32_16x16x32_bf16 v[172:175], a[148:151], v[224:227], v[172:175]
    s_waitcnt vmcnt(14) lgkmcnt(0)
    v_mfma_f32_16x16x32_bf16 a[188:191], a[148:151], v[228:231], a[188:191]
    s_barrier
    v_mfma_f32_16x16x32_bf16 a[236:239], a[148:151], v[232:235], a[236:239]
    ds_read_b128 a[144:147], v252 offset:0
    v_mfma_f32_16x16x32_bf16 v[44:47], a[152:155], v[212:215], v[44:47]
    ds_read_b128 a[148:151], v252 offset:1024
    v_mfma_f32_16x16x32_bf16 v[92:95], a[152:155], v[216:219], v[92:95]
    s_mov_b32 m0, s26
    v_mfma_f32_16x16x32_bf16 v[140:143], a[152:155], v[220:223], v[140:143]
    buffer_load_dwordx4 v254, s[8:11], s25 offen offset:0 nt lds
    v_mfma_f32_16x16x32_bf16 v[188:191], a[152:155], v[224:227], v[188:191]
    s_add_u32 m0, s26, 896
    v_mfma_f32_16x16x32_bf16 a[204:207], a[152:155], v[228:231], a[204:207]
    buffer_load_dwordx4 v254, s[8:11], s25 offen offset:128 nt lds
    v_mfma_f32_16x16x32_bf16 a[252:255], a[152:155], v[232:235], a[252:255]
    ds_read_b128 a[152:155], v252 offset:2048
    v_xor_b32 v252, 64, v252
    v_mfma_f32_16x16x32_bf16 v[8:11], a[156:159], v[212:215], v[8:11]
    s_add_u32 m0, s26, 1792
    v_mfma_f32_16x16x32_bf16 v[56:59], a[156:159], v[216:219], v[56:59]
    buffer_load_dwordx4 v254, s[8:11], s25 offen offset:256 nt lds
    v_mfma_f32_16x16x32_bf16 v[104:107], a[156:159], v[220:223], v[104:107]
    s_add_u32 m0, s26, 36864
    v_mfma_f32_16x16x32_bf16 v[152:155], a[156:159], v[224:227], v[152:155]
    buffer_load_dwordx4 v254, s[12:15], s25 offen offset:0 nt lds
    v_mfma_f32_16x16x32_bf16 v[200:203], a[156:159], v[228:231], v[200:203]
    s_sub_u32 s33, s33, 1
    v_mfma_f32_16x16x32_bf16 a[216:219], a[156:159], v[232:235], a[216:219]
    ds_read_b128 a[156:159], v252 offset:0
    v_mfma_f32_16x16x32_bf16 v[24:27], a[160:163], v[212:215], v[24:27]
    s_add_u32 m0, s26, 37760
    v_mfma_f32_16x16x32_bf16 v[72:75], a[160:163], v[216:219], v[72:75]
    buffer_load_dwordx4 v254, s[12:15], s25 offen offset:128 nt lds
    v_mfma_f32_16x16x32_bf16 v[120:123], a[160:163], v[220:223], v[120:123]
    s_add_u32 m0, s26, 38656
    v_mfma_f32_16x16x32_bf16 v[168:171], a[160:163], v[224:227], v[168:171]
    buffer_load_dwordx4 v254, s[12:15], s25 offen offset:256 nt lds
    v_mfma_f32_16x16x32_bf16 a[184:187], a[160:163], v[228:231], a[184:187]
    s_add_u32 s26, s26, s27
    v_mfma_f32_16x16x32_bf16 a[232:235], a[160:163], v[232:235], a[232:235]
    ds_read_b128 a[160:163], v252 offset:1024
    v_mfma_f32_16x16x32_bf16 v[40:43], a[164:167], v[212:215], v[40:43]
    v_mfma_f32_16x16x32_bf16 v[88:91], a[164:167], v[216:219], v[88:91]
    v_mfma_f32_16x16x32_bf16 v[136:139], a[164:167], v[220:223], v[136:139]
    s_add_u32 s25, s25, 24576
    v_mfma_f32_16x16x32_bf16 v[184:187], a[164:167], v[224:227], v[184:187]
    v_mfma_f32_16x16x32_bf16 a[200:203], a[164:167], v[228:231], a[200:203]
    s_sub_u32 s27, 0, s27
    v_mfma_f32_16x16x32_bf16 a[248:251], a[164:167], v[232:235], a[248:251]
    s_cmp_lg_u32 s33, 0
    ds_read_b128 a[164:167], v252 offset:2048
    s_waitcnt vmcnt(18)
    v_mbcnt_lo_u32_b32 v224, -1, 0
    v_mbcnt_hi_u32_b32 v224, -1, v224
    s_nop 3
    v_mov_b32 v212, v204
    v_mov_b32 v213, v205
    v_mov_b32 v214, v206
    v_mov_b32 v215, v207
    v_mov_b32 v216, v208
    v_mov_b32 v217, v209
    v_mov_b32 v218, v212
    v_mov_b32 v219, v213
    v_mov_b32 v220, v214
    v_mov_b32 v221, v215
    v_mov_b32 v222, v216
    v_mov_b32 v223, v217
    v_permlane32_swap_b32 v218, v212
    v_permlane32_swap_b32 v219, v213
    v_permlane32_swap_b32 v220, v214
    v_permlane32_swap_b32 v221, v215
    v_permlane32_swap_b32 v222, v216
    v_permlane32_swap_b32 v223, v217
    v_add_f32 v212, v218, v212
    v_add_f32 v213, v219, v213
    v_add_f32 v214, v220, v214
    v_add_f32 v215, v221, v215
    v_add_f32 v216, v222, v216
    v_add_f32 v217, v223, v217
    v_mov_b32 v218, v212
    v_mov_b32 v219, v213
    v_mov_b32 v220, v214
    v_mov_b32 v221, v215
    v_mov_b32 v222, v216
    v_mov_b32 v223, v217
    v_permlane16_swap_b32 v218, v212
    v_permlane16_swap_b32 v219, v213
    v_permlane16_swap_b32 v220, v214
    v_permlane16_swap_b32 v221, v215
    v_permlane16_swap_b32 v222, v216
    v_permlane16_swap_b32 v223, v217
    v_add_f32 v212, v218, v212
    v_add_f32 v213, v219, v213
    v_add_f32 v214, v220, v214
    v_add_f32 v215, v221, v215
    v_add_f32 v216, v222, v216
    v_add_f32 v217, v223, v217
    v_min3_f32 v218, v212, v213, v214
    v_max3_f32 v219, v212, v213, v214
    v_min3_f32 v218, v218, v215, v216
    v_max3_f32 v219, v219, v215, v216
    v_min_f32 v218, v218, v217
    v_max_f32 v219, v219, v217
    v_cmp_nle_f32 vcc, 0x33800000, v218
    s_mov_b64 s[44:45], vcc
    v_cmp_nge_f32 vcc, 0x5f800000, v219
    v_rcp_f32 v212, v212
    v_rcp_f32 v213, v213
    v_rcp_f32 v214, v214
    v_rcp_f32 v215, v215
    v_rcp_f32 v216, v216
    v_rcp_f32 v217, v217
    s_or_b64 vcc, vcc, s[44:45]
    s_cselect_b32 s42, 1, 0
    s_or_b32 s34, s34, s42
    s_add_u32 s43, s37, 1024
    v_and_b32 v226, 7, v224
    v_lshrrev_b32 v227, 4, v224
    v_lshlrev_b32 v227, 3, v227
    v_lshlrev_b32 v236, 4, v226
    v_xor_b32 v227, v227, v236
    v_lshl_add_u32 v227, v226, 7, v227
    v_bfe_u32 v226, v224, 3, 1
    v_xor_b32 v225, v226, v224
    v_lshlrev_b32 v225, 4, v225
    v_add_u32 v229, s36, v225
    v_mul_u32_u24 v228, 3080, v226
    v_add_u32 v228, s36, v228
    v_xor_b32 v240, 0, v227
    v_add_u32 v240, v240, v228
    v_xor_b32 v241, 32, v227
    v_add_u32 v241, v241, v228
    v_xor_b32 v242, 64, v227
    v_add_u32 v242, v242, v228
    v_xor_b32 v243, 96, v227
    v_add_u32 v243, v243, v228
    v_add_u32 v225, s43, v225
    v_mul_u32_u24 v226, 1032, v226
    v_add_u32 v226, s43, v226
    v_xor_b32 v236, 0, v227
    v_add_u32 v236, v236, v226
    v_xor_b32 v237, 32, v227
    v_add_u32 v237, v237, v226
    v_xor_b32 v238, 64, v227
    v_add_u32 v238, v238, v226
    v_xor_b32 v239, 96, v227
    v_add_u32 v239, v239, v226
    s_add_u32 s52, s35, 0
    s_add_u32 s53, s35, 6144
    s_add_u32 s54, s35, 12288
    v_pk_mul_f32 v[0:1], v[0:1], v[212:213] op_sel_hi:[1,0]
    v_pk_mul_f32 v[2:3], v[2:3], v[212:213] op_sel_hi:[1,0]
    v_pk_mul_f32 v[4:5], v[4:5], v[212:213] op_sel_hi:[1,0]
    v_pk_mul_f32 v[6:7], v[6:7], v[212:213] op_sel_hi:[1,0]
    v_pk_mul_f32 v[8:9], v[8:9], v[212:213] op_sel_hi:[1,0]
    v_pk_mul_f32 v[10:11], v[10:11], v[212:213] op_sel_hi:[1,0]
    v_pk_mul_f32 v[12:13], v[12:13], v[212:213] op_sel_hi:[1,0]
    v_pk_mul_f32 v[14:15], v[14:15], v[212:213] op_sel_hi:[1,0]
    v_cvt_pk_bf16_f32 v0, v0, v1
    v_cvt_pk_bf16_f32 v1, v2, v3
    v_cvt_pk_bf16_f32 v2, v4, v5
    v_cvt_pk_bf16_f32 v3, v6, v7
    v_cvt_pk_bf16_f32 v4, v8, v9
    v_cvt_pk_bf16_f32 v5, v10, v11
    v_cvt_pk_bf16_f32 v6, v12, v13
    v_cvt_pk_bf16_f32 v7, v14, v15
    ds_write_b64 v236, v[0:1]
    ds_write_b64 v237, v[2:3]
    ds_write_b64 v238, v[4:5]
    ds_write_b64 v239, v[6:7]
    ds_read_b128 v[8:11], v225
    ds_read2_b64 v[12:15], v225 offset0:129 offset1:130
    v_pk_mul_f32 v[16:17], v[16:17], v[212:213] op_sel_hi:[1,0]
    v_pk_mul_f32 v[18:19], v[18:19], v[212:213] op_sel_hi:[1,0]
    v_pk_mul_f32 v[20:21], v[20:21], v[212:213] op_sel_hi:[1,0]
    v_pk_mul_f32 v[22:23], v[22:23], v[212:213] op_sel_hi:[1,0]
    v_pk_mul_f32 v[24:25], v[24:25], v[212:213] op_sel_hi:[1,0]
    v_pk_mul_f32 v[26:27], v[26:27], v[212:213] op_sel_hi:[1,0]
    v_pk_mul_f32 v[28:29], v[28:29], v[212:213] op_sel_hi:[1,0]
    v_pk_mul_f32 v[30:31], v[30:31], v[212:213] op_sel_hi:[1,0]
    v_cvt_pk_bf16_f32 v16, v16, v17
    v_cvt_pk_bf16_f32 v17, v18, v19
    v_cvt_pk_bf16_f32 v18, v20, v21
    v_cvt_pk_bf16_f32 v19, v22, v23
    v_cvt_pk_bf16_f32 v20, v24, v25
    v_cvt_pk_bf16_f32 v21, v26, v27
    v_cvt_pk_bf16_f32 v22, v28, v29
    v_cvt_pk_bf16_f32 v23, v30, v31
    s_waitcnt lgkmcnt(1)
    buffer_store_dwordx4 v[8:11], v254, s[16:19], s52 offen offset:0 sc1
    s_waitcnt lgkmcnt(0)
    buffer_store_dwordx4 v[12:15], v254, s[16:19], s52 offen offset:3072 sc1
    ds_write_b64 v236, v[16:17]
    ds_write_b64 v237, v[18:19]
    ds_write_b64 v238, v[20:21]
    ds_write_b64 v239, v[22:23]
    ds_read_b128 v[24:27], v225
    ds_read2_b64 v[28:31], v225 offset0:129 offset1:130
    v_pk_mul_f32 v[32:33], v[32:33], v[212:213] op_sel_hi:[1,0]
    v_pk_mul_f32 v[34:35], v[34:35], v[212:213] op_sel_hi:[1,0]
    v_pk_mul_f32 v[36:37], v[36:37], v[212:213] op_sel_hi:[1,0]
    v_pk_mul_f32 v[38:39], v[38:39], v[212:213] op_sel_hi:[1,0]
    v_pk_mul_f32 v[40:41], v[40:41], v[212:213] op_sel_hi:[1,0]
    v_pk_mul_f32 v[42:43], v[42:43], v[212:213] op_sel_hi:[1,0]
    v_pk_mul_f32 v[44:45], v[44:45], v[212:213] op_sel_hi:[1,0]
    v_pk_mul_f32 v[46:47], v[46:47], v[212:213] op_sel_hi:[1,0]
    v_cvt_pk_bf16_f32 v32, v32, v33
    v_cvt_pk_bf16_f32 v33, v34, v35
    v_cvt_pk_bf16_f32 v34, v36, v37
    v_cvt_pk_bf16_f32 v35, v38, v39
    v_cvt_pk_bf16_f32 v36, v40, v41
    v_cvt_pk_bf16_f32 v37, v42, v43
    v_cvt_pk_bf16_f32 v38, v44, v45
    v_cvt_pk_bf16_f32 v39, v46, v47
    s_waitcnt lgkmcnt(1)
    buffer_store_dwordx4 v[24:27], v254, s[16:19], s52 offen offset:128 sc1
    s_waitcnt lgkmcnt(0)
    buffer_store_dwordx4 v[28:31], v254, s[16:19], s52 offen offset:3200 sc1
    ds_write_b64 v236, v[32:33]
    ds_write_b64 v237, v[34:35]
    ds_write_b64 v238, v[36:37]
    ds_write_b64 v239, v[38:39]
    ds_read_b128 v[40:43], v225
    ds_read2_b64 v[44:47], v225 offset0:129 offset1:130
    v_accvgpr_read_b32 v0, a224
    v_accvgpr_read_b32 v1, a225
    v_accvgpr_read_b32 v2, a226
    v_accvgpr_read_b32 v3, a227
    v_accvgpr_read_b32 v4, a228
    v_accvgpr_read_b32 v5, a229
    v_accvgpr_read_b32 v6, a230
    v_accvgpr_read_b32 v7, a231
    v_accvgpr_read_b32 v16, a232
    v_accvgpr_read_b32 v17, a233
    v_accvgpr_read_b32 v18, a234
    v_accvgpr_read_b32 v19, a235
    v_accvgpr_read_b32 v20, a236
    v_accvgpr_read_b32 v21, a237
    v_accvgpr_read_b32 v22, a238
    v_accvgpr_read_b32 v23, a239
    v_pk_mul_f32 v[0:1], v[0:1], v[216:217] op_sel:[0,1] op_sel_hi:[1,1]
    v_pk_mul_f32 v[2:3], v[2:3], v[216:217] op_sel:[0,1] op_sel_hi:[1,1]
    v_pk_mul_f32 v[4:5], v[4:5], v[216:217] op_sel:[0,1] op_sel_hi:[1,1]
    v_pk_mul_f32 v[6:7], v[6:7], v[216:217] op_sel:[0,1] op_sel_hi:[1,1]
    v_pk_mul_f32 v[16:17], v[16:17], v[216:217] op_sel:[0,1] op_sel_hi:[1,1]
    v_pk_mul_f32 v[18:19], v[18:19], v[216:217] op_sel:[0,1] op_sel_hi:[1,1]
    v_pk_mul_f32 v[20:21], v[20:21], v[216:217] op_sel:[0,1] op_sel_hi:[1,1]
    v_pk_mul_f32 v[22:23], v[22:23], v[216:217] op_sel:[0,1] op_sel_hi:[1,1]
    v_cvt_pk_bf16_f32 v0, v0, v1
    v_cvt_pk_bf16_f32 v1, v2, v3
    v_cvt_pk_bf16_f32 v2, v4, v5
    v_cvt_pk_bf16_f32 v3, v6, v7
    v_cvt_pk_bf16_f32 v4, v16, v17
    v_cvt_pk_bf16_f32 v5, v18, v19
    v_cvt_pk_bf16_f32 v6, v20, v21
    v_cvt_pk_bf16_f32 v7, v22, v23
    s_waitcnt lgkmcnt(1)
    buffer_store_dwordx4 v[40:43], v254, s[16:19], s52 offen offset:256 sc1
    s_waitcnt lgkmcnt(0)
    buffer_store_dwordx4 v[44:47], v254, s[16:19], s52 offen offset:3328 sc1
    ds_write_b64 v240, v[0:1] offset:13344
    ds_write_b64 v241, v[2:3] offset:13344
    ds_write_b64 v242, v[4:5] offset:13344
    ds_write_b64 v243, v[6:7] offset:13344
    v_pk_mul_f32 v[48:49], v[48:49], v[212:213] op_sel:[0,1] op_sel_hi:[1,1]
    v_pk_mul_f32 v[50:51], v[50:51], v[212:213] op_sel:[0,1] op_sel_hi:[1,1]
    v_pk_mul_f32 v[52:53], v[52:53], v[212:213] op_sel:[0,1] op_sel_hi:[1,1]
    v_pk_mul_f32 v[54:55], v[54:55], v[212:213] op_sel:[0,1] op_sel_hi:[1,1]
    v_pk_mul_f32 v[56:57], v[56:57], v[212:213] op_sel:[0,1] op_sel_hi:[1,1]
    v_pk_mul_f32 v[58:59], v[58:59], v[212:213] op_sel:[0,1] op_sel_hi:[1,1]
    v_pk_mul_f32 v[60:61], v[60:61], v[212:213] op_sel:[0,1] op_sel_hi:[1,1]
    v_pk_mul_f32 v[62:63], v[62:63], v[212:213] op_sel:[0,1] op_sel_hi:[1,1]
    v_cvt_pk_bf16_f32 v48, v48, v49
    v_cvt_pk_bf16_f32 v49, v50, v51
    v_cvt_pk_bf16_f32 v50, v52, v53
    v_cvt_pk_bf16_f32 v51, v54, v55
    v_cvt_pk_bf16_f32 v52, v56, v57
    v_cvt_pk_bf16_f32 v53, v58, v59
    v_cvt_pk_bf16_f32 v54, v60, v61
    v_cvt_pk_bf16_f32 v55, v62, v63
    ds_write_b64 v236, v[48:49]
    ds_write_b64 v237, v[50:51]
    ds_write_b64 v238, v[52:53]
    ds_write_b64 v239, v[54:55]
    ds_read_b128 v[56:59], v225
    ds_read2_b64 v[60:63], v225 offset0:129 offset1:130
    v_accvgpr_read_b32 v32, a240
    v_accvgpr_read_b32 v33, a241
    v_accvgpr_read_b32 v34, a242
    v_accvgpr_read_b32 v35, a243
    v_accvgpr_read_b32 v36, a244
    v_accvgpr_read_b32 v37, a245
    v_accvgpr_read_b32 v38, a246
    v_accvgpr_read_b32 v39, a247
    v_accvgpr_read_b32 v16, a248
    v_accvgpr_read_b32 v17, a249
    v_accvgpr_read_b32 v18, a250
    v_accvgpr_read_b32 v19, a251
    v_accvgpr_read_b32 v20, a252
    v_accvgpr_read_b32 v21, a253
    v_accvgpr_read_b32 v22, a254
    v_accvgpr_read_b32 v23, a255
    v_pk_mul_f32 v[32:33], v[32:33], v[216:217] op_sel:[0,1] op_sel_hi:[1,1]
    v_pk_mul_f32 v[34:35], v[34:35], v[216:217] op_sel:[0,1] op_sel_hi:[1,1]
    v_pk_mul_f32 v[36:37], v[36:37], v[216:217] op_sel:[0,1] op_sel_hi:[1,1]
    v_pk_mul_f32 v[38:39], v[38:39], v[216:217] op_sel:[0,1] op_sel_hi:[1,1]
    v_pk_mul_f32 v[16:17], v[16:17], v[216:217] op_sel:[0,1] op_sel_hi:[1,1]
    v_pk_mul_f32 v[18:19], v[18:19], v[216:217] op_sel:[0,1] op_sel_hi:[1,1]
    v_pk_mul_f32 v[20:21], v[20:21], v[216:217] op_sel:[0,1] op_sel_hi:[1,1]
    v_pk_mul_f32 v[22:23], v[22:23], v[216:217] op_sel:[0,1] op_sel_hi:[1,1]
    v_cvt_pk_bf16_f32 v32, v32, v33
    v_cvt_pk_bf16_f32 v33, v34, v35
    v_cvt_pk_bf16_f32 v34, v36, v37
    v_cvt_pk_bf16_f32 v35, v38, v39
    v_cvt_pk_bf16_f32 v36, v16, v17
    v_cvt_pk_bf16_f32 v37, v18, v19
    v_cvt_pk_bf16_f32 v38, v20, v21
    v_cvt_pk_bf16_f32 v39, v22, v23
    s_waitcnt lgkmcnt(1)
    buffer_store_dwordx4 v[56:59], v254, s[16:19], s53 offen offset:0 sc1
    s_waitcnt lgkmcnt(0)
    buffer_store_dwordx4 v[60:63], v254, s[16:19], s53 offen offset:3072 sc1
    ds_write_b64 v240, v[32:33] offset:14368
    ds_write_b64 v241, v[34:35] offset:14368
    ds_write_b64 v242, v[36:37] offset:14368
    ds_write_b64 v243, v[38:39] offset:14368
    v_pk_mul_f32 v[64:65], v[64:65], v[212:213] op_sel:[0,1] op_sel_hi:[1,1]
    v_pk_mul_f32 v[66:67], v[66:67], v[212:213] op_sel:[0,1] op_sel_hi:[1,1]
    v_pk_mul_f32 v[68:69], v[68:69], v[212:213] op_sel:[0,1] op_sel_hi:[1,1]
    v_pk_mul_f32 v[70:71], v[70:71], v[212:213] op_sel:[0,1] op_sel_hi:[1,1]
    v_pk_mul_f32 v[72:73], v[72:73], v[212:213] op_sel:[0,1] op_sel_hi:[1,1]
    v_pk_mul_f32 v[74:75], v[74:75], v[212:213] op_sel:[0,1] op_sel_hi:[1,1]
    v_pk_mul_f32 v[76:77], v[76:77], v[212:213] op_sel:[0,1] op_sel_hi:[1,1]
    v_pk_mul_f32 v[78:79], v[78:79], v[212:213] op_sel:[0,1] op_sel_hi:[1,1]
    v_cvt_pk_bf16_f32 v64, v64, v65
    v_cvt_pk_bf16_f32 v65, v66, v67
    v_cvt_pk_bf16_f32 v66, v68, v69
    v_cvt_pk_bf16_f32 v67, v70, v71
    v_cvt_pk_bf16_f32 v68, v72, v73
    v_cvt_pk_bf16_f32 v69, v74, v75
    v_cvt_pk_bf16_f32 v70, v76, v77
    v_cvt_pk_bf16_f32 v71, v78, v79
    ds_write_b64 v236, v[64:65]
    ds_write_b64 v237, v[66:67]
    ds_write_b64 v238, v[68:69]
    ds_write_b64 v239, v[70:71]
    ds_read_b128 v[72:75], v225
    ds_read2_b64 v[76:79], v225 offset0:129 offset1:130
    v_pk_mul_f32 v[80:81], v[80:81], v[212:213] op_sel:[0,1] op_sel_hi:[1,1]
    v_pk_mul_f32 v[82:83], v[82:83], v[212:213] op_sel:[0,1] op_sel_hi:[1,1]
    v_pk_mul_f32 v[84:85], v[84:85], v[212:213] op_sel:[0,1] op_sel_hi:[1,1]
    v_pk_mul_f32 v[86:87], v[86:87], v[212:213] op_sel:[0,1] op_sel_hi:[1,1]
    v_pk_mul_f32 v[88:89], v[88:89], v[212:213] op_sel:[0,1] op_sel_hi:[1,1]
    v_pk_mul_f32 v[90:91], v[90:91], v[212:213] op_sel:[0,1] op_sel_hi:[1,1]
    v_pk_mul_f32 v[92:93], v[92:93], v[212:213] op_sel:[0,1] op_sel_hi:[1,1]
    v_pk_mul_f32 v[94:95], v[94:95], v[212:213] op_sel:[0,1] op_sel_hi:[1,1]
    v_cvt_pk_bf16_f32 v80, v80, v81
    v_cvt_pk_bf16_f32 v81, v82, v83
    v_cvt_pk_bf16_f32 v82, v84, v85
    v_cvt_pk_bf16_f32 v83, v86, v87
    v_cvt_pk_bf16_f32 v84, v88, v89
    v_cvt_pk_bf16_f32 v85, v90, v91
    v_cvt_pk_bf16_f32 v86, v92, v93
    v_cvt_pk_bf16_f32 v87, v94, v95
    s_waitcnt lgkmcnt(1)
    buffer_store_dwordx4 v[72:75], v254, s[16:19], s53 offen offset:128 sc1
    s_waitcnt lgkmcnt(0)
    buffer_store_dwordx4 v[76:79], v254, s[16:19], s53 offen offset:3200 sc1
    ds_write_b64 v236, v[80:81]
    ds_write_b64 v237, v[82:83]
    ds_write_b64 v238, v[84:85]
    ds_write_b64 v239, v[86:87]
    ds_read_b128 v[88:91], v225
    ds_read2_b64 v[92:95], v225 offset0:129 offset1:130
    v_pk_mul_f32 v[96:97], v[96:97], v[214:215] op_sel_hi:[1,0]
    v_pk_mul_f32 v[98:99], v[98:99], v[214:215] op_sel_hi:[1,0]
    v_pk_mul_f32 v[100:101], v[100:101], v[214:215] op_sel_hi:[1,0]
    v_pk_mul_f32 v[102:103], v[102:103], v[214:215] op_sel_hi:[1,0]
    v_pk_mul_f32 v[104:105], v[104:105], v[214:215] op_sel_hi:[1,0]
    v_pk_mul_f32 v[106:107], v[106:107], v[214:215] op_sel_hi:[1,0]
    v_pk_mul_f32 v[108:109], v[108:109], v[214:215] op_sel_hi:[1,0]
    v_pk_mul_f32 v[110:111], v[110:111], v[214:215] op_sel_hi:[1,0]
    v_cvt_pk_bf16_f32 v96, v96, v97
    v_cvt_pk_bf16_f32 v97, v98, v99
    v_cvt_pk_bf16_f32 v98, v100, v101
    v_cvt_pk_bf16_f32 v99, v102, v103
    v_cvt_pk_bf16_f32 v100, v104, v105
    v_cvt_pk_bf16_f32 v101, v106, v107
    v_cvt_pk_bf16_f32 v102, v108, v109
    v_cvt_pk_bf16_f32 v103, v110, v111
    s_waitcnt lgkmcnt(1)
    buffer_store_dwordx4 v[88:91], v254, s[16:19], s53 offen offset:256 sc1
    s_waitcnt lgkmcnt(0)
    buffer_store_dwordx4 v[92:95], v254, s[16:19], s53 offen offset:3328 sc1
    ds_write_b64 v236, v[96:97]
    ds_write_b64 v237, v[98:99]
    ds_write_b64 v238, v[100:101]
    ds_write_b64 v239, v[102:103]
    ds_read_b128 v[104:107], v225
    ds_read2_b64 v[108:111], v225 offset0:129 offset1:130
    s_waitcnt vmcnt(18)
    ds_read_b128 a[96:99], v255 offset:0
    ds_read_b128 a[104:107], v255 offset:1024
    ds_read_b128 a[112:115], v255 offset:2048
    v_xor_b32 v255, 64, v255
    ds_read_b128 a[100:103], v255 offset:0
    ds_read_b128 a[108:111], v255 offset:1024
    ds_read_b128 a[116:119], v255 offset:2048
    ds_read_b128 a[124:127], v255 offset:6144
    ds_read_b128 a[132:135], v255 offset:7168
    ds_read_b128 a[140:143], v255 offset:8192
    v_xor_b32 v255, 64, v255
    ds_read_b128 a[120:123], v255 offset:6144
    ds_read_b128 a[128:131], v255 offset:7168
    ds_read_b128 a[136:139], v255 offset:8192
    v_mov_b32 v255, v229
    v_pk_mul_f32 v[144:145], v[144:145], v[214:215] op_sel:[0,1] op_sel_hi:[1,1]
    v_pk_mul_f32 v[146:147], v[146:147], v[214:215] op_sel:[0,1] op_sel_hi:[1,1]
    v_pk_mul_f32 v[148:149], v[148:149], v[214:215] op_sel:[0,1] op_sel_hi:[1,1]
    v_pk_mul_f32 v[150:151], v[150:151], v[214:215] op_sel:[0,1] op_sel_hi:[1,1]
    v_pk_mul_f32 v[152:153], v[152:153], v[214:215] op_sel:[0,1] op_sel_hi:[1,1]
    v_pk_mul_f32 v[154:155], v[154:155], v[214:215] op_sel:[0,1] op_sel_hi:[1,1]
    v_pk_mul_f32 v[156:157], v[156:157], v[214:215] op_sel:[0,1] op_sel_hi:[1,1]
    v_pk_mul_f32 v[158:159], v[158:159], v[214:215] op_sel:[0,1] op_sel_hi:[1,1]
    v_cvt_pk_bf16_f32 v144, v144, v145
    v_cvt_pk_bf16_f32 v145, v146, v147
    v_cvt_pk_bf16_f32 v146, v148, v149
    v_cvt_pk_bf16_f32 v147, v150, v151
    v_cvt_pk_bf16_f32 v148, v152, v153
    v_cvt_pk_bf16_f32 v149, v154, v155
    v_cvt_pk_bf16_f32 v150, v156, v157
    v_cvt_pk_bf16_f32 v151, v158, v159
    ds_write_b64 v240, v[144:145] offset:0
    ds_write_b64 v241, v[146:147] offset:0
    ds_write_b64 v242, v[148:149] offset:0
    ds_write_b64 v243, v[150:151] offset:0
    v_pk_mul_f32 v[112:113], v[112:113], v[214:215] op_sel_hi:[1,0]
    v_pk_mul_f32 v[114:115], v[114:115], v[214:215] op_sel_hi:[1,0]
    v_pk_mul_f32 v[116:117], v[116:117], v[214:215] op_sel_hi:[1,0]
    v_pk_mul_f32 v[118:119], v[118:119], v[214:215] op_sel_hi:[1,0]
    v_pk_mul_f32 v[120:121], v[120:121], v[214:215] op_sel_hi:[1,0]
    v_pk_mul_f32 v[122:123], v[122:123], v[214:215] op_sel_hi:[1,0]
    v_pk_mul_f32 v[124:125], v[124:125], v[214:215] op_sel_hi:[1,0]
    v_pk_mul_f32 v[126:127], v[126:127], v[214:215] op_sel_hi:[1,0]
    v_cvt_pk_bf16_f32 v112, v112, v113
    v_cvt_pk_bf16_f32 v113, v114, v115
    v_cvt_pk_bf16_f32 v114, v116, v117
    v_cvt_pk_bf16_f32 v115, v118, v119
    v_cvt_pk_bf16_f32 v116, v120, v121
    v_cvt_pk_bf16_f32 v117, v122, v123
    v_cvt_pk_bf16_f32 v118, v124, v125
    v_cvt_pk_bf16_f32 v119, v126, v127
    ds_write_b64 v236, v[112:113]
    ds_write_b64 v237, v[114:115]
    ds_write_b64 v238, v[116:117]
    ds_write_b64 v239, v[118:119]
    ds_read_b128 v[120:123], v225
    ds_read2_b64 v[124:127], v225 offset0:129 offset1:130
    s_add_u32 m0, s26, 24576
    s_sub_u32 s44, s25, 12288
    buffer_load_dwordx4 v254, s[8:11], s44 offen offset:0 nt lds
    v_pk_mul_f32 v[160:161], v[160:161], v[214:215] op_sel:[0,1] op_sel_hi:[1,1]
    v_pk_mul_f32 v[162:163], v[162:163], v[214:215] op_sel:[0,1] op_sel_hi:[1,1]
    v_pk_mul_f32 v[164:165], v[164:165], v[214:215] op_sel:[0,1] op_sel_hi:[1,1]
    v_pk_mul_f32 v[166:167], v[166:167], v[214:215] op_sel:[0,1] op_sel_hi:[1,1]
    v_pk_mul_f32 v[168:169], v[168:169], v[214:215] op_sel:[0,1] op_sel_hi:[1,1]
    v_pk_mul_f32 v[170:171], v[170:171], v[214:215] op_sel:[0,1] op_sel_hi:[1,1]
    v_pk_mul_f32 v[172:173], v[172:173], v[214:215] op_sel:[0,1] op_sel_hi:[1,1]
    v_pk_mul_f32 v[174:175], v[174:175], v[214:215] op_sel:[0,1] op_sel_hi:[1,1]
    v_cvt_pk_bf16_f32 v160, v160, v161
    v_cvt_pk_bf16_f32 v161, v162, v163
    v_cvt_pk_bf16_f32 v162, v164, v165
    v_cvt_pk_bf16_f32 v163, v166, v167
    v_cvt_pk_bf16_f32 v164, v168, v169
    v_cvt_pk_bf16_f32 v165, v170, v171
    v_cvt_pk_bf16_f32 v166, v172, v173
    v_cvt_pk_bf16_f32 v167, v174, v175
    ds_write_b64 v240, v[160:161] offset:1024
    ds_write_b64 v241, v[162:163] offset:1024
    ds_write_b64 v242, v[164:165] offset:1024
    ds_write_b64 v243, v[166:167] offset:1024
    s_add_u32 m0, s26, 25472
    s_sub_u32 s44, s25, 12288
    buffer_load_dwordx4 v254, s[8:11], s44 offen offset:128 nt lds
    v_pk_mul_f32 v[128:129], v[128:129], v[214:215] op_sel_hi:[1,0]
    v_pk_mul_f32 v[130:131], v[130:131], v[214:215] op_sel_hi:[1,0]
    v_pk_mul_f32 v[132:133], v[132:133], v[214:215] op_sel_hi:[1,0]
    v_pk_mul_f32 v[134:135], v[134:135], v[214:215] op_sel_hi:[1,0]
    v_pk_mul_f32 v[136:137], v[136:137], v[214:215] op_sel_hi:[1,0]
    v_pk_mul_f32 v[138:139], v[138:139], v[214:215] op_sel_hi:[1,0]
    v_pk_mul_f32 v[140:141], v[140:141], v[214:215] op_sel_hi:[1,0]
    v_pk_mul_f32 v[142:143], v[142:143], v[214:215] op_sel_hi:[1,0]
    v_cvt_pk_bf16_f32 v128, v128, v129
    v_cvt_pk_bf16_f32 v129, v130, v131
    v_cvt_pk_bf16_f32 v130, v132, v133
    v_cvt_pk_bf16_f32 v131, v134, v135
    v_cvt_pk_bf16_f32 v132, v136, v137
    v_cvt_pk_bf16_f32 v133, v138, v139
    v_cvt_pk_bf16_f32 v134, v140, v141
    v_cvt_pk_bf16_f32 v135, v142, v143
    ds_write_b64 v236, v[128:129]
    ds_write_b64 v237, v[130:131]
    ds_write_b64 v238, v[132:133]
    ds_write_b64 v239, v[134:135]
    ds_read_b128 v[136:139], v225
    ds_read2_b64 v[140:143], v225 offset0:129 offset1:130
    s_add_u32 m0, s26, 26368
    s_sub_u32 s44, s25, 12288
    buffer_load_dwordx4 v254, s[8:11], s44 offen offset:256 nt lds
    v_pk_mul_f32 v[176:177], v[176:177], v[214:215] op_sel:[0,1] op_sel_hi:[1,1]
    v_pk_mul_f32 v[178:179], v[178:179], v[214:215] op_sel:[0,1] op_sel_hi:[1,1]
    v_pk_mul_f32 v[180:181], v[180:181], v[214:215] op_sel:[0,1] op_sel_hi:[1,1]
    v_pk_mul_f32 v[182:183], v[182:183], v[214:215] op_sel:[0,1] op_sel_hi:[1,1]
    v_pk_mul_f32 v[184:185], v[184:185], v[214:215] op_sel:[0,1] op_sel_hi:[1,1]
    v_pk_mul_f32 v[186:187], v[186:187], v[214:215] op_sel:[0,1] op_sel_hi:[1,1]
    v_pk_mul_f32 v[188:189], v[188:189], v[214:215] op_sel:[0,1] op_sel_hi:[1,1]
    v_pk_mul_f32 v[190:191], v[190:191], v[214:215] op_sel:[0,1] op_sel_hi:[1,1]
    v_cvt_pk_bf16_f32 v176, v176, v177
    v_cvt_pk_bf16_f32 v177, v178, v179
    v_cvt_pk_bf16_f32 v178, v180, v181
    v_cvt_pk_bf16_f32 v179, v182, v183
    v_cvt_pk_bf16_f32 v180, v184, v185
    v_cvt_pk_bf16_f32 v181, v186, v187
    v_cvt_pk_bf16_f32 v182, v188, v189
    v_cvt_pk_bf16_f32 v183, v190, v191
    ds_write_b64 v240, v[176:177] offset:2048
    ds_write_b64 v241, v[178:179] offset:2048
    ds_write_b64 v242, v[180:181] offset:2048
    ds_write_b64 v243, v[182:183] offset:2048
    s_add_u32 m0, s26, 61440
    s_sub_u32 s44, s25, 12288
    buffer_load_dwordx4 v254, s[12:15], s44 offen offset:0 nt lds
    v_accvgpr_read_b32 v204, a168
    v_accvgpr_read_b32 v205, a169
    v_accvgpr_read_b32 v206, a170
    v_accvgpr_read_b32 v207, a171
    v_pk_mul_f32 v[192:193], v[192:193], v[216:217] op_sel_hi:[1,0]
    v_pk_mul_f32 v[194:195], v[194:195], v[216:217] op_sel_hi:[1,0]
    v_pk_mul_f32 v[196:197], v[196:197], v[216:217] op_sel_hi:[1,0]
    v_pk_mul_f32 v[198:199], v[198:199], v[216:217] op_sel_hi:[1,0]
    v_pk_mul_f32 v[200:201], v[200:201], v[216:217] op_sel_hi:[1,0]
    v_pk_mul_f32 v[202:203], v[202:203], v[216:217] op_sel_hi:[1,0]
    v_pk_mul_f32 v[204:205], v[204:205], v[216:217] op_sel_hi:[1,0]
    v_pk_mul_f32 v[206:207], v[206:207], v[216:217] op_sel_hi:[1,0]
    v_cvt_pk_bf16_f32 v192, v192, v193
    v_cvt_pk_bf16_f32 v193, v194, v195
    v_cvt_pk_bf16_f32 v194, v196, v197
    v_cvt_pk_bf16_f32 v195, v198, v199
    v_cvt_pk_bf16_f32 v196, v200, v201
    v_cvt_pk_bf16_f32 v197, v202, v203
    v_cvt_pk_bf16_f32 v198, v204, v205
    v_cvt_pk_bf16_f32 v199, v206, v207
    ds_write_b64 v240, v[192:193] offset:6160
    ds_write_b64 v241, v[194:195] offset:6160
    ds_write_b64 v242, v[196:197] offset:6160
    ds_write_b64 v243, v[198:199] offset:6160
    s_add_u32 m0, s26, 62336
    s_sub_u32 s44, s25, 12288
    buffer_load_dwordx4 v254, s[12:15], s44 offen offset:128 nt lds
    v_accvgpr_read_b32 v0, a208
    v_accvgpr_read_b32 v1, a209
    v_accvgpr_read_b32 v2, a210
    v_accvgpr_read_b32 v3, a211
    v_accvgpr_read_b32 v4, a212
    v_accvgpr_read_b32 v5, a213
    v_accvgpr_read_b32 v6, a214
    v_accvgpr_read_b32 v7, a215
    v_accvgpr_read_b32 v16, a216
    v_accvgpr_read_b32 v17, a217
    v_accvgpr_read_b32 v18, a218
    v_accvgpr_read_b32 v19, a219
    v_accvgpr_read_b32 v20, a220
    v_accvgpr_read_b32 v21, a221
    v_accvgpr_read_b32 v22, a222
    v_accvgpr_read_b32 v23, a223
    v_pk_mul_f32 v[0:1], v[0:1], v[216:217] op_sel:[0,1] op_sel_hi:[1,1]
    v_pk_mul_f32 v[2:3], v[2:3], v[216:217] op_sel:[0,1] op_sel_hi:[1,1]
    v_pk_mul_f32 v[4:5], v[4:5], v[216:217] op_sel:[0,1] op_sel_hi:[1,1]
    v_pk_mul_f32 v[6:7], v[6:7], v[216:217] op_sel:[0,1] op_sel_hi:[1,1]
    v_pk_mul_f32 v[16:17], v[16:17], v[216:217] op_sel:[0,1] op_sel_hi:[1,1]
    v_pk_mul_f32 v[18:19], v[18:19], v[216:217] op_sel:[0,1] op_sel_hi:[1,1]
    v_pk_mul_f32 v[20:21], v[20:21], v[216:217] op_sel:[0,1] op_sel_hi:[1,1]
    v_pk_mul_f32 v[22:23], v[22:23], v[216:217] op_sel:[0,1] op_sel_hi:[1,1]
    v_cvt_pk_bf16_f32 v0, v0, v1
    v_cvt_pk_bf16_f32 v1, v2, v3
    v_cvt_pk_bf16_f32 v2, v4, v5
    v_cvt_pk_bf16_f32 v3, v6, v7
    v_cvt_pk_bf16_f32 v4, v16, v17
    v_cvt_pk_bf16_f32 v5, v18, v19
    v_cvt_pk_bf16_f32 v6, v20, v21
    v_cvt_pk_bf16_f32 v7, v22, v23
    ds_write_b64 v240, v[0:1] offset:12320
    ds_write_b64 v241, v[2:3] offset:12320
    ds_write_b64 v242, v[4:5] offset:12320
    ds_write_b64 v243, v[6:7] offset:12320
    s_add_u32 m0, s26, 63232
    s_sub_u32 s44, s25, 12288
    buffer_load_dwordx4 v254, s[12:15], s44 offen offset:256 nt lds
    v_accvgpr_read_b32 v32, a172
    v_accvgpr_read_b32 v33, a173
    v_accvgpr_read_b32 v34, a174
    v_accvgpr_read_b32 v35, a175
    v_accvgpr_read_b32 v36, a180
    v_accvgpr_read_b32 v37, a181
    v_accvgpr_read_b32 v38, a182
    v_accvgpr_read_b32 v39, a183
    v_accvgpr_read_b32 v48, a184
    v_accvgpr_read_b32 v49, a185
    v_accvgpr_read_b32 v50, a186
    v_accvgpr_read_b32 v51, a187
    v_accvgpr_read_b32 v52, a188
    v_accvgpr_read_b32 v53, a189
    v_accvgpr_read_b32 v54, a190
    v_accvgpr_read_b32 v55, a191
    v_pk_mul_f32 v[32:33], v[32:33], v[216:217] op_sel_hi:[1,0]
    v_pk_mul_f32 v[34:35], v[34:35], v[216:217] op_sel_hi:[1,0]
    v_pk_mul_f32 v[36:37], v[36:37], v[216:217] op_sel_hi:[1,0]
    v_pk_mul_f32 v[38:39], v[38:39], v[216:217] op_sel_hi:[1,0]
    v_pk_mul_f32 v[48:49], v[48:49], v[216:217] op_sel_hi:[1,0]
    v_pk_mul_f32 v[50:51], v[50:51], v[216:217] op_sel_hi:[1,0]
    v_pk_mul_f32 v[52:53], v[52:53], v[216:217] op_sel_hi:[1,0]
    v_pk_mul_f32 v[54:55], v[54:55], v[216:217] op_sel_hi:[1,0]
    v_cvt_pk_bf16_f32 v32, v32, v33
    v_cvt_pk_bf16_f32 v33, v34, v35
    v_cvt_pk_bf16_f32 v34, v36, v37
    v_cvt_pk_bf16_f32 v35, v38, v39
    v_cvt_pk_bf16_f32 v36, v48, v49
    v_cvt_pk_bf16_f32 v37, v50, v51
    v_cvt_pk_bf16_f32 v38, v52, v53
    v_cvt_pk_bf16_f32 v39, v54, v55
    ds_write_b64 v240, v[32:33] offset:7184
    ds_write_b64 v241, v[34:35] offset:7184
    ds_write_b64 v242, v[36:37] offset:7184
    ds_write_b64 v243, v[38:39] offset:7184
    v_accvgpr_read_b32 v64, a192
    v_accvgpr_read_b32 v65, a193
    v_accvgpr_read_b32 v66, a194
    v_accvgpr_read_b32 v67, a195
    v_accvgpr_read_b32 v68, a196
    v_accvgpr_read_b32 v69, a197
    v_accvgpr_read_b32 v70, a198
    v_accvgpr_read_b32 v71, a199
    v_accvgpr_read_b32 v80, a200
    v_accvgpr_read_b32 v81, a201
    v_accvgpr_read_b32 v82, a202
    v_accvgpr_read_b32 v83, a203
    v_accvgpr_read_b32 v84, a204
    v_accvgpr_read_b32 v85, a205
    v_accvgpr_read_b32 v86, a206
    v_accvgpr_read_b32 v87, a207
    v_pk_mul_f32 v[64:65], v[64:65], v[216:217] op_sel_hi:[1,0]
    v_pk_mul_f32 v[66:67], v[66:67], v[216:217] op_sel_hi:[1,0]
    v_pk_mul_f32 v[68:69], v[68:69], v[216:217] op_sel_hi:[1,0]
    v_pk_mul_f32 v[70:71], v[70:71], v[216:217] op_sel_hi:[1,0]
    v_pk_mul_f32 v[80:81], v[80:81], v[216:217] op_sel_hi:[1,0]
    v_pk_mul_f32 v[82:83], v[82:83], v[216:217] op_sel_hi:[1,0]
    v_pk_mul_f32 v[84:85], v[84:85], v[216:217] op_sel_hi:[1,0]
    v_pk_mul_f32 v[86:87], v[86:87], v[216:217] op_sel_hi:[1,0]
    v_cvt_pk_bf16_f32 v64, v64, v65
    v_cvt_pk_bf16_f32 v65, v66, v67
    v_cvt_pk_bf16_f32 v66, v68, v69
    v_cvt_pk_bf16_f32 v67, v70, v71
    v_cvt_pk_bf16_f32 v68, v80, v81
    v_cvt_pk_bf16_f32 v69, v82, v83
    v_cvt_pk_bf16_f32 v70, v84, v85
    v_cvt_pk_bf16_f32 v71, v86, v87
    ds_write_b64 v240, v[64:65] offset:8208
    ds_write_b64 v241, v[66:67] offset:8208
    ds_write_b64 v242, v[68:69] offset:8208
    ds_write_b64 v243, v[70:71] offset:8208
    s_waitcnt lgkmcnt(0)
    s_add_u32 s32, s35, 18432
    s_mov_b32 s28, 0
    s_mov_b32 s39, 1032
    s_add_u32 s35, s35, 147456
    v_mfma_f32_16x16x32_bf16 v[212:215], a[144:147], a[0:3], 0
    v_mfma_f32_16x16x32_bf16 v[212:215], a[148:151], a[8:11], v[212:215]
    v_mfma_f32_16x16x32_bf16 v[212:215], a[152:155], a[16:19], v[212:215]
    v_mfma_f32_16x16x32_bf16 v[212:215], a[156:159], a[4:7], v[212:215]
    v_mfma_f32_16x16x32_bf16 v[212:215], a[160:163], a[12:15], v[212:215]
    v_mfma_f32_16x16x32_bf16 v[212:215], a[164:167], a[20:23], v[212:215]
    v_mfma_f32_16x16x32_bf16 v[216:219], a[144:147], a[24:27], 0
    buffer_store_dwordx4 v[104:107], v254, s[16:19], s54 offen offset:0 sc1
    v_mfma_f32_16x16x32_bf16 v[216:219], a[148:151], a[32:35], v[216:219]
    v_mul_f32 v212, s24, v212
    v_mul_f32 v213, s24, v213
    v_mfma_f32_16x16x32_bf16 v[216:219], a[152:155], a[40:43], v[216:219]
    v_mul_f32 v214, s24, v214
    v_mul_f32 v215, s24, v215
    v_mfma_f32_16x16x32_bf16 v[216:219], a[156:159], a[28:31], v[216:219]
    v_exp_f32 v212, v212
    v_mfma_f32_16x16x32_bf16 v[216:219], a[160:163], a[36:39], v[216:219]
    v_exp_f32 v213, v213
    v_mfma_f32_16x16x32_bf16 v[216:219], a[164:167], a[44:47], v[216:219]
    v_exp_f32 v214, v214
    v_mfma_f32_16x16x32_bf16 v[220:223], a[144:147], a[48:51], 0
    v_exp_f32 v215, v215
    v_mfma_f32_16x16x32_bf16 v[220:223], a[148:151], a[56:59], v[220:223]
    v_cvt_pk_bf16_f32 v212, v212, v213
    v_mul_f32 v216, s24, v216
    v_mfma_f32_16x16x32_bf16 v[220:223], a[152:155], a[64:67], v[220:223]
    s_cmp_eq_u32 s26, s46
    v_cvt_pk_bf16_f32 v213, v214, v215
    v_mul_f32 v217, s24, v217
    v_mfma_f32_16x16x32_bf16 v[220:223], a[156:159], a[52:55], v[220:223]
    s_cselect_b32 s27, s47, 12288
    v_mul_f32 v218, s24, v218
    v_mul_f32 v219, s24, v219
    v_mfma_f32_16x16x32_bf16 v[220:223], a[160:163], a[60:63], v[220:223]
    v_exp_f32 v216, v216
    v_mfma_f32_16x16x32_bf16 v[220:223], a[164:167], a[68:71], v[220:223]
    v_exp_f32 v217, v217
    v_mfma_f32_16x16x32_bf16 v[224:227], a[144:147], a[72:75], 0
    v_exp_f32 v218, v218
    v_mfma_f32_16x16x32_bf16 v[224:227], a[148:151], a[80:83], v[224:227]
    v_cvt_pk_bf16_f32 v216, v216, v217
    v_mul_f32 v220, s24, v220
    v_mfma_f32_16x16x32_bf16 v[224:227], a[152:155], a[88:91], v[224:227]
    v_mul_f32 v221, s24, v221
    v_mul_f32 v222, s24, v222
    v_mfma_f32_16x16x32_bf16 v[224:227], a[156:159], a[76:79], v[224:227]
    v_exp_f32 v219, v219
    v_mfma_f32_16x16x32_bf16 v[224:227], a[160:163], a[84:87], v[224:227]
    v_cvt_pk_bf16_f32 v217, v218, v219
    v_mul_f32 v223, s24, v223
    v_mfma_f32_16x16x32_bf16 v[224:227], a[164:167], a[92:95], v[224:227]
    v_exp_f32 v220, v220
    v_mfma_f32_16x16x32_bf16 v[228:231], a[144:147], a[96:99], 0
    v_exp_f32 v221, v221
    v_mfma_f32_16x16x32_bf16 v[228:231], a[148:151], a[104:107], v[228:231]
    v_cvt_pk_bf16_f32 v220, v220, v221
    v_mul_f32 v224, s24, v224
    v_mfma_f32_16x16x32_bf16 v[228:231], a[152:155], a[112:115], v[228:231]
    buffer_store_dwordx4 v[108:111], v254, s[16:19], s54 offen offset:3072 sc1
    v_mul_f32 v225, s24, v225
    v_mfma_f32_16x16x32_bf16 v[228:231], a[156:159], a[100:103], v[228:231]
    v_mul_f32 v226, s24, v226
    v_mul_f32 v227, s24, v227
    v_mfma_f32_16x16x32_bf16 v[228:231], a[160:163], a[108:111], v[228:231]
    v_exp_f32 v222, v222
    v_mfma_f32_16x16x32_bf16 v[228:231], a[164:167], a[116:119], v[228:231]
    v_exp_f32 v223, v223
    v_mfma_f32_16x16x32_bf16 v[232:235], a[144:147], a[120:123], 0
    ds_read_b128 a[144:147], v252 offset:6144
    v_cvt_pk_bf16_f32 v221, v222, v223
    v_mfma_f32_16x16x32_bf16 v[232:235], a[148:151], a[128:131], v[232:235]
    ds_read_b128 a[148:151], v252 offset:7168
    v_mul_f32 v228, s24, v228
    v_mfma_f32_16x16x32_bf16 v[232:235], a[152:155], a[136:139], v[232:235]
    ds_read_b128 a[152:155], v252 offset:8192
    v_xor_b32 v252, 64, v252
    v_mfma_f32_16x16x32_bf16 v[232:235], a[156:159], a[124:127], v[232:235]
    ds_read_b128 a[156:159], v252 offset:6144
    v_mul_f32 v229, s24, v229
    v_mfma_f32_16x16x32_bf16 v[232:235], a[160:163], a[132:135], v[232:235]
    ds_read_b128 a[160:163], v252 offset:7168
    v_mul_f32 v230, s24, v230
    v_mfma_f32_16x16x32_bf16 v[232:235], a[164:167], a[140:143], v[232:235]
    s_waitcnt lgkmcnt(4)
    ds_read_b128 a[164:167], v252 offset:8192
    v_mul_f32 v231, s24, v231
    v_mfma_f32_16x16x32_bf16 v[236:239], a[144:147], a[4:7], 0
    s_waitcnt lgkmcnt(4)
    v_exp_f32 v224, v224
    v_mfma_f32_16x16x32_bf16 v[236:239], a[148:151], a[12:15], v[236:239]
    s_waitcnt lgkmcnt(3)
    v_mul_f32 v232, s24, v232
    v_mul_f32 v233, s24, v233
    v_mfma_f32_16x16x32_bf16 v[236:239], a[152:155], a[20:23], v[236:239]
    s_waitcnt lgkmcnt(2)
    v_mul_f32 v234, s24, v234
    v_mul_f32 v235, s24, v235
    v_mfma_f32_16x16x32_bf16 v[236:239], a[156:159], a[0:3], v[236:239]
    s_waitcnt lgkmcnt(1)
    v_exp_f32 v225, v225
    v_mfma_f32_16x16x32_bf16 v[236:239], a[160:163], a[8:11], v[236:239]
    s_waitcnt lgkmcnt(0)
    v_exp_f32 v226, v226
    v_mfma_f32_16x16x32_bf16 v[236:239], a[164:167], a[16:19], v[236:239]
    v_exp_f32 v227, v227
    v_mfma_f32_16x16x32_bf16 v[240:243], a[144:147], a[28:31], 0
    v_cvt_pk_bf16_f32 v224, v224, v225
    v_cvt_pk_bf16_f32 v225, v226, v227
    v_mfma_f32_16x16x32_bf16 v[240:243], a[148:151], a[36:39], v[240:243]
    v_mul_f32 v236, s24, v236
    v_mul_f32 v237, s24, v237
    v_mfma_f32_16x16x32_bf16 v[240:243], a[152:155], a[44:47], v[240:243]
    v_exp_f32 v228, v228
    v_mfma_f32_16x16x32_bf16 v[240:243], a[156:159], a[24:27], v[240:243]
    v_exp_f32 v229, v229
    v_mfma_f32_16x16x32_bf16 v[240:243], a[160:163], a[32:35], v[240:243]
    buffer_store_dwordx4 v[120:123], v254, s[16:19], s54 offen offset:128 sc1
    v_cvt_pk_bf16_f32 v228, v228, v229
    v_mfma_f32_16x16x32_bf16 v[240:243], a[164:167], a[40:43], v[240:243]
    v_mul_f32 v238, s24, v238
    v_mul_f32 v239, s24, v239
    v_mfma_f32_16x16x32_bf16 v[244:247], a[144:147], a[52:55], 0
    v_exp_f32 v230, v230
    v_mfma_f32_16x16x32_bf16 v[244:247], a[148:151], a[60:63], v[244:247]
    v_exp_f32 v231, v231
    v_mfma_f32_16x16x32_bf16 v[244:247], a[152:155], a[68:71], v[244:247]
    v_exp_f32 v232, v232
    v_mfma_f32_16x16x32_bf16 v[244:247], a[156:159], a[48:51], v[244:247]
    v_exp_f32 v233, v233
    v_mfma_f32_16x16x32_bf16 v[244:247], a[160:163], a[56:59], v[244:247]
    v_cvt_pk_bf16_f32 v229, v230, v231
    v_cvt_pk_bf16_f32 v232, v232, v233
    v_mfma_f32_16x16x32_bf16 v[244:247], a[164:167], a[64:67], v[244:247]
    v_exp_f32 v234, v234
    v_mfma_f32_16x16x32_bf16 v[248:251], a[144:147], a[76:79], 0
    v_exp_f32 v235, v235
    v_mfma_f32_16x16x32_bf16 v[248:251], a[148:151], a[84:87], v[248:251]
    v_exp_f32 v236, v236
    v_mfma_f32_16x16x32_bf16 v[248:251], a[152:155], a[92:95], v[248:251]
    v_exp_f32 v237, v237
    v_mfma_f32_16x16x32_bf16 v[248:251], a[156:159], a[72:75], v[248:251]
    v_exp_f32 v238, v238
    v_mfma_f32_16x16x32_bf16 v[248:251], a[160:163], a[80:83], v[248:251]
    v_cvt_pk_bf16_f32 v233, v234, v235
    v_exp_f32 v239, v239
    v_mfma_f32_16x16x32_bf16 v[248:251], a[164:167], a[88:91], v[248:251]
    v_cvt_pk_bf16_f32 v214, v236, v237
    v_cvt_pk_bf16_f32 v215, v238, v239
    v_mfma_f32_16x16x32_bf16 v[236:239], a[144:147], a[100:103], 0
    v_mul_f32 v240, s24, v240
    v_mul_f32 v241, s24, v241
    v_mfma_f32_16x16x32_bf16 v[236:239], a[148:151], a[108:111], v[236:239]
    v_mul_f32 v242, s24, v242
    v_mul_f32 v243, s24, v243
    v_mfma_f32_16x16x32_bf16 v[236:239], a[152:155], a[116:119], v[236:239]
    v_exp_f32 v240, v240
    v_mfma_f32_16x16x32_bf16 v[236:239], a[156:159], a[96:99], v[236:239]
    v_exp_f32 v241, v241
    v_mfma_f32_16x16x32_bf16 v[236:239], a[160:163], a[104:107], v[236:239]
    v_exp_f32 v242, v242
    v_exp_f32 v243, v243
    v_mfma_f32_16x16x32_bf16 v[236:239], a[164:167], a[112:115], v[236:239]
    v_cvt_pk_bf16_f32 v218, v240, v241
    v_cvt_pk_bf16_f32 v219, v242, v243
    v_mfma_f32_16x16x32_bf16 v[240:243], a[144:147], a[124:127], 0
    ds_read_b64_tr_b16 a[144:145], v253 offset:0
    buffer_store_dwordx4 v[124:127], v254, s[16:19], s54 offen offset:3200 sc1
    v_mfma_f32_16x16x32_bf16 v[240:243], a[148:151], a[132:135], v[240:243]
    ds_read_b64_tr_b16 a[146:147], v253 offset:6144
    v_mul_f32 v244, s24, v244
    v_mfma_f32_16x16x32_bf16 v[240:243], a[152:155], a[140:143], v[240:243]
    ds_read_b64_tr_b16 a[148:149], v253 offset:1024
    v_mul_f32 v245, s24, v245
    v_mfma_f32_16x16x32_bf16 v[240:243], a[156:159], a[120:123], v[240:243]
    ds_read_b64_tr_b16 a[150:151], v253 offset:7168
    v_mul_f32 v246, s24, v246
    v_mfma_f32_16x16x32_bf16 v[240:243], a[160:163], a[128:131], v[240:243]
    ds_read_b64_tr_b16 a[152:153], v253 offset:2048
    v_mul_f32 v247, s24, v247
    v_mfma_f32_16x16x32_bf16 v[240:243], a[164:167], a[136:139], v[240:243]
    s_waitcnt lgkmcnt(3)
    ds_read_b64_tr_b16 a[154:155], v253 offset:8192
    v_xor_b32 v253, 32, v253
    v_mfma_f32_16x16x32_bf16 v[0:3], a[144:147], v[212:215], 0
    ds_read_b64_tr_b16 a[156:157], v253 offset:0
    v_mul_f32 v248, s24, v248
    v_mfma_f32_16x16x32_bf16 v[48:51], a[144:147], v[216:219], 0
    s_waitcnt lgkmcnt(3)
    ds_read_b64_tr_b16 a[158:159], v253 offset:6144
    v_mul_f32 v249, s24, v249
    v_mfma_f32_16x16x32_bf16 v[16:19], a[148:151], v[212:215], 0
    ds_read_b64_tr_b16 a[160:161], v253 offset:1024
    v_mul_f32 v250, s24, v250
    v_mfma_f32_16x16x32_bf16 v[64:67], a[148:151], v[216:219], 0
    s_waitcnt lgkmcnt(3)
    ds_read_b64_tr_b16 a[162:163], v253 offset:7168
    v_mul_f32 v251, s24, v251
    v_mfma_f32_16x16x32_bf16 v[32:35], a[152:155], v[212:215], 0
    ds_read_b64_tr_b16 a[164:165], v253 offset:2048
    v_mul_f32 v236, s24, v236
    v_mfma_f32_16x16x32_bf16 v[80:83], a[152:155], v[216:219], 0
    s_waitcnt lgkmcnt(3)
    ds_read_b64_tr_b16 a[166:167], v253 offset:8192
    v_xor_b32 v253, 64, v253
    v_mfma_f32_16x16x32_bf16 v[4:7], a[156:159], v[212:215], 0
    v_exp_f32 v244, v244
    v_mfma_f32_16x16x32_bf16 v[52:55], a[156:159], v[216:219], 0
    s_waitcnt lgkmcnt(2)
    v_exp_f32 v245, v245
    v_mfma_f32_16x16x32_bf16 v[20:23], a[160:163], v[212:215], 0
    v_exp_f32 v246, v246
    v_mfma_f32_16x16x32_bf16 v[68:71], a[160:163], v[216:219], 0
    s_waitcnt lgkmcnt(0)
    v_exp_f32 v247, v247
    v_mfma_f32_16x16x32_bf16 v[36:39], a[164:167], v[212:215], 0
    v_cvt_pk_bf16_f32 v222, v244, v245
    v_cvt_pk_bf16_f32 v223, v246, v247
    v_mfma_f32_16x16x32_bf16 v[84:87], a[164:167], v[216:219], 0
    v_exp_f32 v248, v248
    v_mfma_f32_16x16x32_bf16 v[96:99], a[144:147], v[220:223], 0
    v_exp_f32 v249, v249
    v_mfma_f32_16x16x32_bf16 v[112:115], a[148:151], v[220:223], 0
    v_exp_f32 v250, v250
    v_mfma_f32_16x16x32_bf16 v[128:131], a[152:155], v[220:223], 0
    buffer_store_dwordx4 v[136:139], v254, s[16:19], s54 offen offset:256 sc1
    v_cvt_pk_bf16_f32 v226, v248, v249
    v_mfma_f32_16x16x32_bf16 v[100:103], a[156:159], v[220:223], 0
    v_exp_f32 v251, v251
    v_mfma_f32_16x16x32_bf16 v[116:119], a[160:163], v[220:223], 0
    v_cvt_pk_bf16_f32 v227, v250, v251
    v_mul_f32 v237, s24, v237
    v_mfma_f32_16x16x32_bf16 v[132:135], a[164:167], v[220:223], 0
    v_mul_f32 v238, s24, v238
    v_mul_f32 v239, s24, v239
    v_mfma_f32_16x16x32_bf16 v[144:147], a[144:147], v[224:227], 0
    v_exp_f32 v236, v236
    v_mfma_f32_16x16x32_bf16 v[160:163], a[148:151], v[224:227], 0
    v_exp_f32 v237, v237
    v_mfma_f32_16x16x32_bf16 v[176:179], a[152:155], v[224:227], 0
    v_exp_f32 v238, v238
    v_mfma_f32_16x16x32_bf16 v[148:151], a[156:159], v[224:227], 0
    v_exp_f32 v239, v239
    v_mfma_f32_16x16x32_bf16 v[164:167], a[160:163], v[224:227], 0
    v_cvt_pk_bf16_f32 v230, v236, v237
    v_cvt_pk_bf16_f32 v231, v238, v239
    v_mfma_f32_16x16x32_bf16 v[180:183], a[164:167], v[224:227], 0
    v_mul_f32 v240, s24, v240
    v_mul_f32 v241, s24, v241
    v_mfma_f32_16x16x32_bf16 v[192:195], a[144:147], v[228:231], 0
    v_mul_f32 v242, s24, v242
    v_mul_f32 v243, s24, v243
    v_mfma_f32_16x16x32_bf16 v[208:211], a[148:151], v[228:231], 0
    v_exp_f32 v240, v240
    v_mfma_f32_16x16x32_bf16 a[192:195], a[152:155], v[228:231], 0
    v_exp_f32 v241, v241
    v_mfma_f32_16x16x32_bf16 v[196:199], a[156:159], v[228:231], 0
    v_exp_f32 v242, v242
    v_exp_f32 v243, v243
    v_mfma_f32_16x16x32_bf16 a[180:183], a[160:163], v[228:231], 0
    v_cvt_pk_bf16_f32 v234, v240, v241
    v_cvt_pk_bf16_f32 v235, v242, v243
    v_mfma_f32_16x16x32_bf16 a[196:199], a[164:167], v[228:231], 0
    v_mfma_f32_16x16x32_bf16 a[208:211], a[144:147], v[232:235], 0
    ds_read_b64_tr_b16 a[144:145], v253 offset:0
    v_mfma_f32_16x16x32_bf16 a[224:227], a[148:151], v[232:235], 0
    ds_read_b64_tr_b16 a[146:147], v253 offset:6144
    v_mfma_f32_16x16x32_bf16 a[240:243], a[152:155], v[232:235], 0
    ds_read_b64_tr_b16 a[148:149], v253 offset:1024
    v_mfma_f32_16x16x32_bf16 a[212:215], a[156:159], v[232:235], 0
    ds_read_b64_tr_b16 a[150:151], v253 offset:7168
    v_mfma_f32_16x16x32_bf16 a[228:231], a[160:163], v[232:235], 0
    ds_read_b64_tr_b16 a[152:153], v253 offset:2048
    buffer_store_dwordx4 v[140:143], v254, s[16:19], s54 offen offset:3328 sc1
    v_mfma_f32_16x16x32_bf16 a[244:247], a[164:167], v[232:235], 0
    s_waitcnt lgkmcnt(3)
    ds_read_b64_tr_b16 a[154:155], v253 offset:8192
    v_xor_b32 v253, 32, v253
    v_mfma_f32_16x16x32_bf16 v[12:15], a[144:147], v[212:215], 0
    ds_read_b64_tr_b16 a[156:157], v253 offset:0
    v_mfma_f32_16x16x32_bf16 v[60:63], a[144:147], v[216:219], 0
    ds_read_b64_tr_b16 a[158:159], v253 offset:6144
    v_mfma_f32_16x16x32_bf16 v[108:111], a[144:147], v[220:223], 0
    ds_read_b64_tr_b16 a[160:161], v253 offset:1024
    v_mfma_f32_16x16x32_bf16 v[156:159], a[144:147], v[224:227], 0
    ds_read_b64_tr_b16 a[162:163], v253 offset:7168
    v_mfma_f32_16x16x32_bf16 v[204:207], a[144:147], v[228:231], 0
    ds_read_b64_tr_b16 a[164:165], v253 offset:2048
    v_add_u32 v252, s27, v252
    v_mfma_f32_16x16x32_bf16 a[220:223], a[144:147], v[232:235], 0
    s_waitcnt lgkmcnt(7)
    ds_read_b64_tr_b16 a[166:167], v253 offset:8192
    v_xad_u32 v253, v253, 64, s27
    v_mfma_f32_16x16x32_bf16 v[28:31], a[148:151], v[212:215], 0
    ds_read_b128 v[240:243], v255 offset:0
    v_mfma_f32_16x16x32_bf16 v[76:79], a[148:151], v[216:219], 0
    ds_read_b128 v[244:247], v255 offset:1024
    v_mfma_f32_16x16x32_bf16 v[124:127], a[148:151], v[220:223], 0
    ds_read_b128 v[248:251], v255 offset:2048
    v_add_u32 v255, 3080, v255
    v_mfma_f32_16x16x32_bf16 v[172:175], a[148:151], v[224:227], 0
    s_waitcnt vmcnt(24) lgkmcnt(3)
    v_mfma_f32_16x16x32_bf16 a[188:191], a[148:151], v[228:231], 0
    s_barrier
    v_mfma_f32_16x16x32_bf16 a[236:239], a[148:151], v[232:235], 0
    ds_read_b128 a[144:147], v252 offset:0
    v_mfma_f32_16x16x32_bf16 v[44:47], a[152:155], v[212:215], 0
    ds_read_b128 a[148:151], v252 offset:1024
    v_mfma_f32_16x16x32_bf16 v[92:95], a[152:155], v[216:219], 0
    s_mov_b32 m0, s26
    v_mfma_f32_16x16x32_bf16 v[140:143], a[152:155], v[220:223], 0
    buffer_load_dwordx4 v254, s[8:11], s25 offen offset:0 nt lds
    v_mfma_f32_16x16x32_bf16 v[188:191], a[152:155], v[224:227], 0
    s_add_u32 m0, s26, 896
    v_mfma_f32_16x16x32_bf16 a[204:207], a[152:155], v[228:231], 0
    buffer_load_dwordx4 v254, s[8:11], s25 offen offset:128 nt lds
    v_mfma_f32_16x16x32_bf16 a[252:255], a[152:155], v[232:235], 0
    ds_read_b128 a[152:155], v252 offset:2048
    v_xor_b32 v252, 64, v252
    v_mfma_f32_16x16x32_bf16 v[8:11], a[156:159], v[212:215], 0
    s_add_u32 m0, s26, 1792
    v_mfma_f32_16x16x32_bf16 v[56:59], a[156:159], v[216:219], 0
    buffer_load_dwordx4 v254, s[8:11], s25 offen offset:256 nt lds
    v_mfma_f32_16x16x32_bf16 v[104:107], a[156:159], v[220:223], 0
    s_add_u32 m0, s26, 36864
    v_mfma_f32_16x16x32_bf16 v[152:155], a[156:159], v[224:227], 0
    buffer_load_dwordx4 v254, s[12:15], s25 offen offset:0 nt lds
    v_mfma_f32_16x16x32_bf16 v[200:203], a[156:159], v[228:231], 0
    v_mfma_f32_16x16x32_bf16 a[216:219], a[156:159], v[232:235], 0
    ds_read_b128 a[156:159], v252 offset:0
    v_mfma_f32_16x16x32_bf16 v[24:27], a[160:163], v[212:215], 0
    s_add_u32 m0, s26, 37760
    v_mfma_f32_16x16x32_bf16 v[72:75], a[160:163], v[216:219], 0
    buffer_load_dwordx4 v254, s[12:15], s25 offen offset:128 nt lds
    v_mfma_f32_16x16x32_bf16 v[120:123], a[160:163], v[220:223], 0
    s_add_u32 m0, s26, 38656
    v_mfma_f32_16x16x32_bf16 v[168:171], a[160:163], v[224:227], 0
    buffer_load_dwordx4 v254, s[12:15], s25 offen offset:256 nt lds
    v_mfma_f32_16x16x32_bf16 a[184:187], a[160:163], v[228:231], 0
    v_mfma_f32_16x16x32_bf16 a[232:235], a[160:163], v[232:235], 0
    s_waitcnt lgkmcnt(4)
    ds_read_b128 a[160:163], v252 offset:1024
    v_mfma_f32_16x16x32_bf16 v[40:43], a[164:167], v[212:215], 0
    v_mfma_f32_16x16x32_bf16 v[88:91], a[164:167], v[216:219], 0
    buffer_store_dwordx4 v[240:243], v254, s[16:19], s32 offen offset:0 sc1
    v_mfma_f32_16x16x32_bf16 v[136:139], a[164:167], v[220:223], 0
    v_mfma_f32_16x16x32_bf16 v[184:187], a[164:167], v[224:227], 0
    buffer_store_dwordx4 v[244:247], v254, s[16:19], s32 offen offset:128 sc1
    v_mfma_f32_16x16x32_bf16 a[200:203], a[164:167], v[228:231], 0
    buffer_store_dwordx4 v[248:251], v254, s[16:19], s32 offen offset:256 sc1
    v_mfma_f32_16x16x32_bf16 a[248:251], a[164:167], v[232:235], 0
    ds_read_b128 a[164:167], v252 offset:2048
    v_mfma_f32_4x4x4_16b_bf16 a[168:171], a[176:177], v[212:213], 0 cbsz:4 abid:0
    v_mfma_f32_4x4x4_16b_bf16 a[172:175], a[176:177], v[224:225], 0 cbsz:4 abid:0
    s_add_u32 s26, s26, s27
    v_mfma_f32_4x4x4_16b_bf16 a[168:171], a[176:177], v[214:215], a[168:171] cbsz:4 abid:0
    v_mfma_f32_4x4x4_16b_bf16 a[172:175], a[176:177], v[226:227], a[172:175] cbsz:4 abid:0
    s_add_u32 s25, s25, 12288
    v_mfma_f32_4x4x4_16b_bf16 a[168:171], a[176:177], v[216:217], a[168:171] cbsz:4 abid:1
    v_mfma_f32_4x4x4_16b_bf16 a[172:175], a[176:177], v[228:229], a[172:175] cbsz:4 abid:1
    s_add_u32 s32, s32, 3072
    v_mfma_f32_4x4x4_16b_bf16 a[168:171], a[176:177], v[218:219], a[168:171] cbsz:4 abid:1
    v_mfma_f32_4x4x4_16b_bf16 a[172:175], a[176:177], v[230:231], a[172:175] cbsz:4 abid:1
    s_sub_u32 s33, s33, 1
    v_mfma_f32_4x4x4_16b_bf16 a[168:171], a[176:177], v[220:221], a[168:171] cbsz:4 abid:2
    v_mfma_f32_4x4x4_16b_bf16 a[172:175], a[176:177], v[232:233], a[172:175] cbsz:4 abid:2
    s_cmp_lg_u32 s33, 0
    v_mfma_f32_4x4x4_16b_bf16 a[168:171], a[176:177], v[222:223], a[168:171] cbsz:4 abid:2
    v_mfma_f32_4x4x4_16b_bf16 a[172:175], a[176:177], v[234:235], a[172:175] cbsz:4 abid:2
    s_mov_b32 s33, 15
.p2align 6
L_loop2:
    s_waitcnt lgkmcnt(1)
    v_mfma_f32_16x16x32_bf16 v[212:215], a[144:147], a[0:3], 0
    v_mfma_f32_16x16x32_bf16 v[212:215], a[148:151], a[8:11], v[212:215]
    v_mfma_f32_16x16x32_bf16 v[212:215], a[152:155], a[16:19], v[212:215]
    v_mfma_f32_16x16x32_bf16 v[212:215], a[156:159], a[4:7], v[212:215]
    v_mfma_f32_16x16x32_bf16 v[212:215], a[160:163], a[12:15], v[212:215]
    s_waitcnt lgkmcnt(0)
    v_mfma_f32_16x16x32_bf16 v[212:215], a[164:167], a[20:23], v[212:215]
    v_mfma_f32_16x16x32_bf16 v[216:219], a[144:147], a[24:27], 0
    v_mfma_f32_16x16x32_bf16 v[216:219], a[148:151], a[32:35], v[216:219]
    v_mul_f32 v212, s24, v212
    v_mul_f32 v213, s24, v213
    v_mfma_f32_16x16x32_bf16 v[216:219], a[152:155], a[40:43], v[216:219]
    s_add_u32 s28, s28, 1
    v_mul_f32 v214, s24, v214
    v_mul_f32 v215, s24, v215
    v_mfma_f32_16x16x32_bf16 v[216:219], a[156:159], a[28:31], v[216:219]
    s_cmp_eq_u32 s28, 3
    v_exp_f32 v212, v212
    v_mfma_f32_16x16x32_bf16 v[216:219], a[160:163], a[36:39], v[216:219]
    s_cselect_b32 s28, 0, s28
    v_exp_f32 v213, v213
    v_mfma_f32_16x16x32_bf16 v[216:219], a[164:167], a[44:47], v[216:219]
    s_cselect_b32 s29, s48, 128
    v_exp_f32 v214, v214
    v_mfma_f32_16x16x32_bf16 v[220:223], a[144:147], a[48:51], 0
    s_cselect_b32 s30, s39, 1024
    v_exp_f32 v215, v215
    v_mfma_f32_16x16x32_bf16 v[220:223], a[148:151], a[56:59], v[220:223]
    v_cvt_pk_bf16_f32 v212, v212, v213
    v_mul_f32 v216, s24, v216
    v_mfma_f32_16x16x32_bf16 v[220:223], a[152:155], a[64:67], v[220:223]
    s_cmp_eq_u32 s26, s46
    v_cvt_pk_bf16_f32 v213, v214, v215
    v_mul_f32 v217, s24, v217
    v_mfma_f32_16x16x32_bf16 v[220:223], a[156:159], a[52:55], v[220:223]
    s_cselect_b32 s27, s47, 12288
    v_mul_f32 v218, s24, v218
    v_mul_f32 v219, s24, v219
    v_mfma_f32_16x16x32_bf16 v[220:223], a[160:163], a[60:63], v[220:223]
    v_exp_f32 v216, v216
    v_mfma_f32_16x16x32_bf16 v[220:223], a[164:167], a[68:71], v[220:223]
    v_exp_f32 v217, v217
    v_mfma_f32_16x16x32_bf16 v[224:227], a[144:147], a[72:75], 0
    v_exp_f32 v218, v218
    v_mfma_f32_16x16x32_bf16 v[224:227], a[148:151], a[80:83], v[224:227]
    v_cvt_pk_bf16_f32 v216, v216, v217
    v_mul_f32 v220, s24, v220
    v_mfma_f32_16x16x32_bf16 v[224:227], a[152:155], a[88:91], v[224:227]
    v_mul_f32 v221, s24, v221
    v_mul_f32 v222, s24, v222
    v_mfma_f32_16x16x32_bf16 v[224:227], a[156:159], a[76:79], v[224:227]
    v_exp_f32 v219, v219
    v_mfma_f32_16x16x32_bf16 v[224:227], a[160:163], a[84:87], v[224:227]
    v_cvt_pk_bf16_f32 v217, v218, v219
    v_mul_f32 v223, s24, v223
    v_mfma_f32_16x16x32_bf16 v[224:227], a[164:167], a[92:95], v[224:227]
    v_exp_f32 v220, v220
    v_mfma_f32_16x16x32_bf16 v[228:231], a[144:147], a[96:99], 0
    v_exp_f32 v221, v221
    v_mfma_f32_16x16x32_bf16 v[228:231], a[148:151], a[104:107], v[228:231]
    v_cvt_pk_bf16_f32 v220, v220, v221
    v_mul_f32 v224, s24, v224
    v_mfma_f32_16x16x32_bf16 v[228:231], a[152:155], a[112:115], v[228:231]
    v_mul_f32 v225, s24, v225
    v_mul_f32 v226, s24, v226
    v_mfma_f32_16x16x32_bf16 v[228:231], a[156:159], a[100:103], v[228:231]
    v_exp_f32 v222, v222
    v_mfma_f32_16x16x32_bf16 v[228:231], a[160:163], a[108:111], v[228:231]
    v_exp_f32 v223, v223
    v_mfma_f32_16x16x32_bf16 v[228:231], a[164:167], a[116:119], v[228:231]
    v_exp_f32 v224, v224
    v_mfma_f32_16x16x32_bf16 v[232:235], a[144:147], a[120:123], 0
    ds_read_b128 a[144:147], v252 offset:6144
    v_cvt_pk_bf16_f32 v221, v222, v223
    v_mfma_f32_16x16x32_bf16 v[232:235], a[148:151], a[128:131], v[232:235]
    ds_read_b128 a[148:151], v252 offset:7168
    v_mul_f32 v227, s24, v227
    v_mfma_f32_16x16x32_bf16 v[232:235], a[152:155], a[136:139], v[232:235]
    ds_read_b128 a[152:155], v252 offset:8192
    v_xor_b32 v252, 64, v252
    v_mfma_f32_16x16x32_bf16 v[232:235], a[156:159], a[124:127], v[232:235]
    ds_read_b128 a[156:159], v252 offset:6144
    v_mul_f32 v228, s24, v228
    v_mfma_f32_16x16x32_bf16 v[232:235], a[160:163], a[132:135], v[232:235]
    ds_read_b128 a[160:163], v252 offset:7168
    v_mul_f32 v229, s24, v229
    v_mfma_f32_16x16x32_bf16 v[232:235], a[164:167], a[140:143], v[232:235]
    s_waitcnt lgkmcnt(4)
    ds_read_b128 a[164:167], v252 offset:8192
    v_mul_f32 v230, s24, v230
    v_mfma_f32_16x16x32_bf16 v[236:239], a[144:147], a[4:7], 0
    s_waitcnt lgkmcnt(4)
    v_exp_f32 v225, v225
    v_mfma_f32_16x16x32_bf16 v[236:239], a[148:151], a[12:15], v[236:239]
    s_waitcnt lgkmcnt(3)
    v_cvt_pk_bf16_f32 v224, v224, v225
    v_mul_f32 v231, s24, v231
    v_mfma_f32_16x16x32_bf16 v[236:239], a[152:155], a[20:23], v[236:239]
    s_waitcnt lgkmcnt(2)
    v_mul_f32 v232, s24, v232
    v_mul_f32 v233, s24, v233
    v_mfma_f32_16x16x32_bf16 v[236:239], a[156:159], a[0:3], v[236:239]
    s_waitcnt lgkmcnt(1)
    v_mul_f32 v234, s24, v234
    v_mul_f32 v235, s24, v235
    v_mfma_f32_16x16x32_bf16 v[236:239], a[160:163], a[8:11], v[236:239]
    s_waitcnt lgkmcnt(0)
    v_exp_f32 v226, v226
    v_mfma_f32_16x16x32_bf16 v[236:239], a[164:167], a[16:19], v[236:239]
    v_exp_f32 v227, v227
    v_mfma_f32_16x16x32_bf16 v[240:243], a[144:147], a[28:31], 0
    v_exp_f32 v228, v228
    v_mfma_f32_16x16x32_bf16 v[240:243], a[148:151], a[36:39], v[240:243]
    v_cvt_pk_bf16_f32 v225, v226, v227
    v_mul_f32 v236, s24, v236
    v_mfma_f32_16x16x32_bf16 v[240:243], a[152:155], a[44:47], v[240:243]
    v_mul_f32 v237, s24, v237
    v_mul_f32 v238, s24, v238
    v_mfma_f32_16x16x32_bf16 v[240:243], a[156:159], a[24:27], v[240:243]
    v_exp_f32 v229, v229
    v_mfma_f32_16x16x32_bf16 v[240:243], a[160:163], a[32:35], v[240:243]
    v_cvt_pk_bf16_f32 v228, v228, v229
    v_mul_f32 v239, s24, v239
    v_mfma_f32_16x16x32_bf16 v[240:243], a[164:167], a[40:43], v[240:243]
    v_exp_f32 v230, v230
    v_mfma_f32_16x16x32_bf16 v[244:247], a[144:147], a[52:55], 0
    v_exp_f32 v231, v231
    v_mfma_f32_16x16x32_bf16 v[244:247], a[148:151], a[60:63], v[244:247]
    v_cvt_pk_bf16_f32 v229, v230, v231
    v_mul_f32 v240, s24, v240
    v_mfma_f32_16x16x32_bf16 v[244:247], a[152:155], a[68:71], v[244:247]
    v_exp_f32 v232, v232
    v_mfma_f32_16x16x32_bf16 v[244:247], a[156:159], a[48:51], v[244:247]
    v_exp_f32 v233, v233
    v_mfma_f32_16x16x32_bf16 v[244:247], a[160:163], a[56:59], v[244:247]
    v_exp_f32 v234, v234
    v_mfma_f32_16x16x32_bf16 v[244:247], a[164:167], a[64:67], v[244:247]
    v_exp_f32 v235, v235
    v_mfma_f32_16x16x32_bf16 v[248:251], a[144:147], a[76:79], 0
    v_cvt_pk_bf16_f32 v232, v232, v233
    v_cvt_pk_bf16_f32 v233, v234, v235
    v_mfma_f32_16x16x32_bf16 v[248:251], a[148:151], a[84:87], v[248:251]
    v_exp_f32 v236, v236
    v_mfma_f32_16x16x32_bf16 v[248:251], a[152:155], a[92:95], v[248:251]
    v_exp_f32 v237, v237
    v_mfma_f32_16x16x32_bf16 v[248:251], a[156:159], a[72:75], v[248:251]
    v_exp_f32 v238, v238
    v_mfma_f32_16x16x32_bf16 v[248:251], a[160:163], a[80:83], v[248:251]
    v_exp_f32 v239, v239
    v_mfma_f32_16x16x32_bf16 v[248:251], a[164:167], a[88:91], v[248:251]
    v_cvt_pk_bf16_f32 v214, v236, v237
    v_cvt_pk_bf16_f32 v215, v238, v239
    v_mfma_f32_16x16x32_bf16 v[236:239], a[144:147], a[100:103], 0
    v_mul_f32 v241, s24, v241
    v_mul_f32 v242, s24, v242
    v_mfma_f32_16x16x32_bf16 v[236:239], a[148:151], a[108:111], v[236:239]
    v_exp_f32 v240, v240
    v_mfma_f32_16x16x32_bf16 v[236:239], a[152:155], a[116:119], v[236:239]
    v_exp_f32 v241, v241
    v_mfma_f32_16x16x32_bf16 v[236:239], a[156:159], a[96:99], v[236:239]
    v_exp_f32 v242, v242
    v_mfma_f32_16x16x32_bf16 v[236:239], a[160:163], a[104:107], v[236:239]
    v_mul_f32 v243, s24, v243
    v_exp_f32 v243, v243
    v_mfma_f32_16x16x32_bf16 v[236:239], a[164:167], a[112:115], v[236:239]
    v_cvt_pk_bf16_f32 v218, v240, v241
    v_cvt_pk_bf16_f32 v219, v242, v243
    v_mfma_f32_16x16x32_bf16 v[240:243], a[144:147], a[124:127], 0
    ds_read_b64_tr_b16 a[144:145], v253 offset:0
    v_mul_f32 v244, s24, v244
    v_mfma_f32_16x16x32_bf16 v[240:243], a[148:151], a[132:135], v[240:243]
    ds_read_b64_tr_b16 a[146:147], v253 offset:6144
    v_mul_f32 v245, s24, v245
    v_mfma_f32_16x16x32_bf16 v[240:243], a[152:155], a[140:143], v[240:243]
    ds_read_b64_tr_b16 a[148:149], v253 offset:1024
    v_mul_f32 v246, s24, v246
    v_mfma_f32_16x16x32_bf16 v[240:243], a[156:159], a[120:123], v[240:243]
    ds_read_b64_tr_b16 a[150:151], v253 offset:7168
    v_mul_f32 v247, s24, v247
    v_mfma_f32_16x16x32_bf16 v[240:243], a[160:163], a[128:131], v[240:243]
    ds_read_b64_tr_b16 a[152:153], v253 offset:2048
    v_mul_f32 v248, s24, v248
    v_mfma_f32_16x16x32_bf16 v[240:243], a[164:167], a[136:139], v[240:243]
    s_waitcnt lgkmcnt(3)
    ds_read_b64_tr_b16 a[154:155], v253 offset:8192
    v_xor_b32 v253, 32, v253
    v_mfma_f32_16x16x32_bf16 v[0:3], a[144:147], v[212:215], v[0:3]
    ds_read_b64_tr_b16 a[156:157], v253 offset:0
    v_mul_f32 v249, s24, v249
    v_mfma_f32_16x16x32_bf16 v[48:51], a[144:147], v[216:219], v[48:51]
    s_waitcnt lgkmcnt(3)
    ds_read_b64_tr_b16 a[158:159], v253 offset:6144
    v_mul_f32 v250, s24, v250
    v_mfma_f32_16x16x32_bf16 v[16:19], a[148:151], v[212:215], v[16:19]
    ds_read_b64_tr_b16 a[160:161], v253 offset:1024
    v_mul_f32 v251, s24, v251
    v_mfma_f32_16x16x32_bf16 v[64:67], a[148:151], v[216:219], v[64:67]
    s_waitcnt lgkmcnt(3)
    ds_read_b64_tr_b16 a[162:163], v253 offset:7168
    v_mul_f32 v236, s24, v236
    v_mfma_f32_16x16x32_bf16 v[32:35], a[152:155], v[212:215], v[32:35]
    ds_read_b64_tr_b16 a[164:165], v253 offset:2048
    v_mul_f32 v237, s24, v237
    v_mfma_f32_16x16x32_bf16 v[80:83], a[152:155], v[216:219], v[80:83]
    s_waitcnt lgkmcnt(3)
    ds_read_b64_tr_b16 a[166:167], v253 offset:8192
    v_xor_b32 v253, 64, v253
    v_mfma_f32_16x16x32_bf16 v[4:7], a[156:159], v[212:215], v[4:7]
    v_exp_f32 v244, v244
    v_mfma_f32_16x16x32_bf16 v[52:55], a[156:159], v[216:219], v[52:55]
    s_waitcnt lgkmcnt(2)
    v_exp_f32 v245, v245
    v_mfma_f32_16x16x32_bf16 v[20:23], a[160:163], v[212:215], v[20:23]
    v_exp_f32 v246, v246
    v_mfma_f32_16x16x32_bf16 v[68:71], a[160:163], v[216:219], v[68:71]
    s_waitcnt lgkmcnt(0)
    v_exp_f32 v247, v247
    v_mfma_f32_16x16x32_bf16 v[36:39], a[164:167], v[212:215], v[36:39]
    v_cvt_pk_bf16_f32 v222, v244, v245
    v_cvt_pk_bf16_f32 v223, v246, v247
    v_mfma_f32_16x16x32_bf16 v[84:87], a[164:167], v[216:219], v[84:87]
    v_mul_f32 v238, s24, v238
    v_mul_f32 v239, s24, v239
    v_mfma_f32_16x16x32_bf16 v[96:99], a[144:147], v[220:223], v[96:99]
    v_exp_f32 v248, v248
    v_mfma_f32_16x16x32_bf16 v[112:115], a[148:151], v[220:223], v[112:115]
    v_exp_f32 v249, v249
    v_mfma_f32_16x16x32_bf16 v[128:131], a[152:155], v[220:223], v[128:131]
    v_exp_f32 v250, v250
    v_mfma_f32_16x16x32_bf16 v[100:103], a[156:159], v[220:223], v[100:103]
    v_exp_f32 v251, v251
    v_mfma_f32_16x16x32_bf16 v[116:119], a[160:163], v[220:223], v[116:119]
    v_cvt_pk_bf16_f32 v226, v248, v249
    v_cvt_pk_bf16_f32 v227, v250, v251
    v_mfma_f32_16x16x32_bf16 v[132:135], a[164:167], v[220:223], v[132:135]
    v_mul_f32 v240, s24, v240
    v_mul_f32 v241, s24, v241
    v_mfma_f32_16x16x32_bf16 v[144:147], a[144:147], v[224:227], v[144:147]
    v_exp_f32 v236, v236
    v_mfma_f32_16x16x32_bf16 v[160:163], a[148:151], v[224:227], v[160:163]
    v_exp_f32 v237, v237
    v_mfma_f32_16x16x32_bf16 v[176:179], a[152:155], v[224:227], v[176:179]
    v_exp_f32 v238, v238
    v_mfma_f32_16x16x32_bf16 v[148:151], a[156:159], v[224:227], v[148:151]
    v_exp_f32 v239, v239
    v_mfma_f32_16x16x32_bf16 v[164:167], a[160:163], v[224:227], v[164:167]
    v_cvt_pk_bf16_f32 v230, v236, v237
    v_cvt_pk_bf16_f32 v231, v238, v239
    v_mfma_f32_16x16x32_bf16 v[180:183], a[164:167], v[224:227], v[180:183]
    v_mul_f32 v242, s24, v242
    v_mul_f32 v243, s24, v243
    v_mfma_f32_16x16x32_bf16 v[192:195], a[144:147], v[228:231], v[192:195]
    v_exp_f32 v240, v240
    v_mfma_f32_16x16x32_bf16 v[208:211], a[148:151], v[228:231], v[208:211]
    v_exp_f32 v241, v241
    v_mfma_f32_16x16x32_bf16 a[192:195], a[152:155], v[228:231], a[192:195]
    v_exp_f32 v242, v242
    v_mfma_f32_16x16x32_bf16 v[196:199], a[156:159], v[228:231], v[196:199]
    v_exp_f32 v243, v243
    v_mfma_f32_16x16x32_bf16 a[180:183], a[160:163], v[228:231], a[180:183]
    v_cvt_pk_bf16_f32 v234, v240, v241
    v_cvt_pk_bf16_f32 v235, v242, v243
    v_mfma_f32_16x16x32_bf16 a[196:199], a[164:167], v[228:231], a[196:199]
    v_mfma_f32_16x16x32_bf16 a[208:211], a[144:147], v[232:235], a[208:211]
    ds_read_b64_tr_b16 a[144:145], v253 offset:0
    v_mfma_f32_16x16x32_bf16 a[224:227], a[148:151], v[232:235], a[224:227]
    ds_read_b64_tr_b16 a[146:147], v253 offset:6144
    v_mfma_f32_16x16x32_bf16 a[240:243], a[152:155], v[232:235], a[240:243]
    ds_read_b64_tr_b16 a[148:149], v253 offset:1024
    v_mfma_f32_16x16x32_bf16 a[212:215], a[156:159], v[232:235], a[212:215]
    ds_read_b64_tr_b16 a[150:151], v253 offset:7168
    v_mfma_f32_16x16x32_bf16 a[228:231], a[160:163], v[232:235], a[228:231]
    ds_read_b64_tr_b16 a[152:153], v253 offset:2048
    v_mfma_f32_16x16x32_bf16 a[244:247], a[164:167], v[232:235], a[244:247]
    s_waitcnt lgkmcnt(3)
    ds_read_b64_tr_b16 a[154:155], v253 offset:8192
    v_xor_b32 v253, 32, v253
    v_mfma_f32_16x16x32_bf16 v[12:15], a[144:147], v[212:215], v[12:15]
    ds_read_b64_tr_b16 a[156:157], v253 offset:0
    v_mfma_f32_16x16x32_bf16 v[60:63], a[144:147], v[216:219], v[60:63]
    ds_read_b64_tr_b16 a[158:159], v253 offset:6144
    v_mfma_f32_16x16x32_bf16 v[108:111], a[144:147], v[220:223], v[108:111]
    ds_read_b64_tr_b16 a[160:161], v253 offset:1024
    v_mfma_f32_16x16x32_bf16 v[156:159], a[144:147], v[224:227], v[156:159]
    ds_read_b64_tr_b16 a[162:163], v253 offset:7168
    v_mfma_f32_16x16x32_bf16 v[204:207], a[144:147], v[228:231], v[204:207]
    ds_read_b64_tr_b16 a[164:165], v253 offset:2048
    v_add_u32 v252, s27, v252
    v_mfma_f32_16x16x32_bf16 a[220:223], a[144:147], v[232:235], a[220:223]
    s_waitcnt lgkmcnt(7)
    ds_read_b64_tr_b16 a[166:167], v253 offset:8192
    v_xad_u32 v253, v253, 64, s27
    v_mfma_f32_16x16x32_bf16 v[28:31], a[148:151], v[212:215], v[28:31]
    ds_read2_b64 v[240:243], v255 offset1:1
    v_add_u32 v255, s30, v255
    v_mfma_f32_16x16x32_bf16 v[76:79], a[148:151], v[216:219], v[76:79]
    v_mfma_f32_16x16x32_bf16 v[124:127], a[148:151], v[220:223], v[124:127]
    v_mfma_f32_16x16x32_bf16 v[172:175], a[148:151], v[224:227], v[172:175]
    s_waitcnt vmcnt(8) lgkmcnt(1)
    v_mfma_f32_16x16x32_bf16 a[188:191], a[148:151], v[228:231], a[188:191]
    s_barrier
    v_mfma_f32_16x16x32_bf16 a[236:239], a[148:151], v[232:235], a[236:239]
    ds_read_b128 a[144:147], v252 offset:0
    v_mfma_f32_16x16x32_bf16 v[44:47], a[152:155], v[212:215], v[44:47]
    ds_read_b128 a[148:151], v252 offset:1024
    v_mfma_f32_16x16x32_bf16 v[92:95], a[152:155], v[216:219], v[92:95]
    s_mov_b32 m0, s26
    v_mfma_f32_16x16x32_bf16 v[140:143], a[152:155], v[220:223], v[140:143]
    buffer_load_dwordx4 v254, s[8:11], s25 offen offset:0 nt lds
    v_mfma_f32_16x16x32_bf16 v[188:191], a[152:155], v[224:227], v[188:191]
    s_add_u32 m0, s26, 896
    v_mfma_f32_16x16x32_bf16 a[204:207], a[152:155], v[228:231], a[204:207]
    buffer_load_dwordx4 v254, s[8:11], s25 offen offset:128 nt lds
    v_mfma_f32_16x16x32_bf16 a[252:255], a[152:155], v[232:235], a[252:255]
    ds_read_b128 a[152:155], v252 offset:2048
    v_xor_b32 v252, 64, v252
    v_mfma_f32_16x16x32_bf16 v[8:11], a[156:159], v[212:215], v[8:11]
    s_add_u32 m0, s26, 1792
    v_mfma_f32_16x16x32_bf16 v[56:59], a[156:159], v[216:219], v[56:59]
    buffer_load_dwordx4 v254, s[8:11], s25 offen offset:256 nt lds
    v_mfma_f32_16x16x32_bf16 v[104:107], a[156:159], v[220:223], v[104:107]
    s_add_u32 m0, s26, 36864
    v_mfma_f32_16x16x32_bf16 v[152:155], a[156:159], v[224:227], v[152:155]
    buffer_load_dwordx4 v254, s[12:15], s25 offen offset:0 nt lds
    v_mfma_f32_16x16x32_bf16 v[200:203], a[156:159], v[228:231], v[200:203]
    v_mfma_f32_16x16x32_bf16 a[216:219], a[156:159], v[232:235], a[216:219]
    ds_read_b128 a[156:159], v252 offset:0
    v_mfma_f32_16x16x32_bf16 v[24:27], a[160:163], v[212:215], v[24:27]
    s_add_u32 m0, s26, 37760
    v_mfma_f32_16x16x32_bf16 v[72:75], a[160:163], v[216:219], v[72:75]
    buffer_load_dwordx4 v254, s[12:15], s25 offen offset:128 nt lds
    v_mfma_f32_16x16x32_bf16 v[120:123], a[160:163], v[220:223], v[120:123]
    s_add_u32 m0, s26, 38656
    v_mfma_f32_16x16x32_bf16 v[168:171], a[160:163], v[224:227], v[168:171]
    buffer_load_dwordx4 v254, s[12:15], s25 offen offset:256 nt lds
    v_mfma_f32_16x16x32_bf16 a[184:187], a[160:163], v[228:231], a[184:187]
    v_mfma_f32_16x16x32_bf16 a[232:235], a[160:163], v[232:235], a[232:235]
    s_waitcnt lgkmcnt(4)
    ds_read_b128 a[160:163], v252 offset:1024
    v_mfma_f32_16x16x32_bf16 v[40:43], a[164:167], v[212:215], v[40:43]
    v_mfma_f32_16x16x32_bf16 v[88:91], a[164:167], v[216:219], v[88:91]
    buffer_store_dwordx4 v[240:243], v254, s[16:19], s32 offen offset:0 sc1
    v_mfma_f32_16x16x32_bf16 v[136:139], a[164:167], v[220:223], v[136:139]
    v_mfma_f32_16x16x32_bf16 v[184:187], a[164:167], v[224:227], v[184:187]
    v_mfma_f32_16x16x32_bf16 a[200:203], a[164:167], v[228:231], a[200:203]
    v_mfma_f32_16x16x32_bf16 a[248:251], a[164:167], v[232:235], a[248:251]
    ds_read_b128 a[164:167], v252 offset:2048
    v_mfma_f32_4x4x4_16b_bf16 a[168:171], a[176:177], v[212:213], a[168:171] cbsz:4 abid:0
    v_mfma_f32_4x4x4_16b_bf16 a[172:175], a[176:177], v[224:225], a[172:175] cbsz:4 abid:0
    s_add_u32 s26, s26, s27
    v_mfma_f32_4x4x4_16b_bf16 a[168:171], a[176:177], v[214:215], a[168:171] cbsz:4 abid:0
    v_mfma_f32_4x4x4_16b_bf16 a[172:175], a[176:177], v[226:227], a[172:175] cbsz:4 abid:0
    s_add_u32 s25, s25, 12288
    v_mfma_f32_4x4x4_16b_bf16 a[168:171], a[176:177], v[216:217], a[168:171] cbsz:4 abid:1
    v_mfma_f32_4x4x4_16b_bf16 a[172:175], a[176:177], v[228:229], a[172:175] cbsz:4 abid:1
    s_add_u32 s32, s32, s29
    v_mfma_f32_4x4x4_16b_bf16 a[168:171], a[176:177], v[218:219], a[168:171] cbsz:4 abid:1
    v_mfma_f32_4x4x4_16b_bf16 a[172:175], a[176:177], v[230:231], a[172:175] cbsz:4 abid:1
    s_sub_u32 s33, s33, 1
    v_mfma_f32_4x4x4_16b_bf16 a[168:171], a[176:177], v[220:221], a[168:171] cbsz:4 abid:2
    v_mfma_f32_4x4x4_16b_bf16 a[172:175], a[176:177], v[232:233], a[172:175] cbsz:4 abid:2
    s_cmp_lg_u32 s33, 0
    v_mfma_f32_4x4x4_16b_bf16 a[168:171], a[176:177], v[222:223], a[168:171] cbsz:4 abid:2
    v_mfma_f32_4x4x4_16b_bf16 a[172:175], a[176:177], v[234:235], a[172:175] cbsz:4 abid:2
    s_cbranch_scc1 L_loop2
    v_mbcnt_lo_u32_b32 v224, -1, 0
    v_mbcnt_hi_u32_b32 v224, -1, v224
    s_nop 3
    v_accvgpr_read_b32 v212, a168
    v_accvgpr_read_b32 v213, a169
    v_accvgpr_read_b32 v214, a170
    v_accvgpr_read_b32 v215, a172
    v_accvgpr_read_b32 v216, a173
    v_accvgpr_read_b32 v217, a174
    v_mov_b32 v218, v212
    v_mov_b32 v219, v213
    v_mov_b32 v220, v214
    v_mov_b32 v221, v215
    v_mov_b32 v222, v216
    v_mov_b32 v223, v217
    v_permlane32_swap_b32 v218, v212
    v_permlane32_swap_b32 v219, v213
    v_permlane32_swap_b32 v220, v214
    v_permlane32_swap_b32 v221, v215
    v_permlane32_swap_b32 v222, v216
    v_permlane32_swap_b32 v223, v217
    v_add_f32 v212, v218, v212
    v_add_f32 v213, v219, v213
    v_add_f32 v214, v220, v214
    v_add_f32 v215, v221, v215
    v_add_f32 v216, v222, v216
    v_add_f32 v217, v223, v217
    v_mov_b32 v218, v212
    v_mov_b32 v219, v213
    v_mov_b32 v220, v214
    v_mov_b32 v221, v215
    v_mov_b32 v222, v216
    v_mov_b32 v223, v217
    v_permlane16_swap_b32 v218, v212
    v_permlane16_swap_b32 v219, v213
    v_permlane16_swap_b32 v220, v214
    v_permlane16_swap_b32 v221, v215
    v_permlane16_swap_b32 v222, v216
    v_permlane16_swap_b32 v223, v217
    v_add_f32 v212, v218, v212
    v_add_f32 v213, v219, v213
    v_add_f32 v214, v220, v214
    v_add_f32 v215, v221, v215
    v_add_f32 v216, v222, v216
    v_add_f32 v217, v223, v217
    v_min3_f32 v218, v212, v213, v214
    v_max3_f32 v219, v212, v213, v214
    v_min3_f32 v218, v218, v215, v216
    v_max3_f32 v219, v219, v215, v216
    v_min_f32 v218, v218, v217
    v_max_f32 v219, v219, v217
    v_cmp_nle_f32 vcc, 0x33800000, v218
    s_mov_b64 s[44:45], vcc
    v_cmp_nge_f32 vcc, 0x5f800000, v219
    v_rcp_f32 v212, v212
    v_rcp_f32 v213, v213
    v_rcp_f32 v214, v214
    v_rcp_f32 v215, v215
    v_rcp_f32 v216, v216
    v_rcp_f32 v217, v217
    s_or_b64 vcc, vcc, s[44:45]
    s_cselect_b32 s42, 2, 0
    s_or_b32 s34, s34, s42
    s_add_u32 s43, s37, 1024
    v_and_b32 v226, 7, v224
    v_lshrrev_b32 v227, 4, v224
    v_lshlrev_b32 v227, 3, v227
    v_lshlrev_b32 v236, 4, v226
    v_xor_b32 v227, v227, v236
    v_lshl_add_u32 v227, v226, 7, v227
    v_bfe_u32 v226, v224, 3, 1
    v_xor_b32 v225, v226, v224
    v_lshlrev_b32 v225, 4, v225
    v_add_u32 v225, s43, v225
    v_mul_u32_u24 v226, 1032, v226
    v_add_u32 v226, s43, v226
    v_xor_b32 v236, 0, v227
    v_add_u32 v236, v236, v226
    v_xor_b32 v237, 32, v227
    v_add_u32 v237, v237, v226
    v_xor_b32 v238, 64, v227
    v_add_u32 v238, v238, v226
    v_xor_b32 v239, 96, v227
    v_add_u32 v239, v239, v226
    s_add_u32 s52, s35, 0
    s_add_u32 s53, s35, 6144
    s_add_u32 s54, s35, 12288
    v_pk_mul_f32 v[0:1], v[0:1], v[212:213] op_sel_hi:[1,0]
    v_pk_mul_f32 v[2:3], v[2:3], v[212:213] op_sel_hi:[1,0]
    v_pk_mul_f32 v[4:5], v[4:5], v[212:213] op_sel_hi:[1,0]
    v_pk_mul_f32 v[6:7], v[6:7], v[212:213] op_sel_hi:[1,0]
    v_pk_mul_f32 v[8:9], v[8:9], v[212:213] op_sel_hi:[1,0]
    v_pk_mul_f32 v[10:11], v[10:11], v[212:213] op_sel_hi:[1,0]
    v_pk_mul_f32 v[12:13], v[12:13], v[212:213] op_sel_hi:[1,0]
    v_pk_mul_f32 v[14:15], v[14:15], v[212:213] op_sel_hi:[1,0]
    v_cvt_pk_bf16_f32 v0, v0, v1
    v_cvt_pk_bf16_f32 v1, v2, v3
    v_cvt_pk_bf16_f32 v2, v4, v5
    v_cvt_pk_bf16_f32 v3, v6, v7
    v_cvt_pk_bf16_f32 v4, v8, v9
    v_cvt_pk_bf16_f32 v5, v10, v11
    v_cvt_pk_bf16_f32 v6, v12, v13
    v_cvt_pk_bf16_f32 v7, v14, v15
    ds_write_b64 v236, v[0:1]
    ds_write_b64 v237, v[2:3]
    ds_write_b64 v238, v[4:5]
    ds_write_b64 v239, v[6:7]
    ds_read_b128 v[8:11], v225
    ds_read2_b64 v[12:15], v225 offset0:129 offset1:130
    v_pk_mul_f32 v[16:17], v[16:17], v[212:213] op_sel_hi:[1,0]
    v_pk_mul_f32 v[18:19], v[18:19], v[212:213] op_sel_hi:[1,0]
    v_pk_mul_f32 v[20:21], v[20:21], v[212:213] op_sel_hi:[1,0]
    v_pk_mul_f32 v[22:23], v[22:23], v[212:213] op_sel_hi:[1,0]
    v_pk_mul_f32 v[24:25], v[24:25], v[212:213] op_sel_hi:[1,0]
    v_pk_mul_f32 v[26:27], v[26:27], v[212:213] op_sel_hi:[1,0]
    v_pk_mul_f32 v[28:29], v[28:29], v[212:213] op_sel_hi:[1,0]
    v_pk_mul_f32 v[30:31], v[30:31], v[212:213] op_sel_hi:[1,0]
    v_cvt_pk_bf16_f32 v16, v16, v17
    v_cvt_pk_bf16_f32 v17, v18, v19
    v_cvt_pk_bf16_f32 v18, v20, v21
    v_cvt_pk_bf16_f32 v19, v22, v23
    v_cvt_pk_bf16_f32 v20, v24, v25
    v_cvt_pk_bf16_f32 v21, v26, v27
    v_cvt_pk_bf16_f32 v22, v28, v29
    v_cvt_pk_bf16_f32 v23, v30, v31
    s_waitcnt lgkmcnt(1)
    buffer_store_dwordx4 v[8:11], v254, s[16:19], s52 offen offset:0 sc1
    s_waitcnt lgkmcnt(0)
    buffer_store_dwordx4 v[12:15], v254, s[16:19], s52 offen offset:3072 sc1
    ds_write_b64 v236, v[16:17]
    ds_write_b64 v237, v[18:19]
    ds_write_b64 v238, v[20:21]
    ds_write_b64 v239, v[22:23]
    ds_read_b128 v[24:27], v225
    ds_read2_b64 v[28:31], v225 offset0:129 offset1:130
    v_pk_mul_f32 v[32:33], v[32:33], v[212:213] op_sel_hi:[1,0]
    v_pk_mul_f32 v[34:35], v[34:35], v[212:213] op_sel_hi:[1,0]
    v_pk_mul_f32 v[36:37], v[36:37], v[212:213] op_sel_hi:[1,0]
    v_pk_mul_f32 v[38:39], v[38:39], v[212:213] op_sel_hi:[1,0]
    v_pk_mul_f32 v[40:41], v[40:41], v[212:213] op_sel_hi:[1,0]
    v_pk_mul_f32 v[42:43], v[42:43], v[212:213] op_sel_hi:[1,0]
    v_pk_mul_f32 v[44:45], v[44:45], v[212:213] op_sel_hi:[1,0]
    v_pk_mul_f32 v[46:47], v[46:47], v[212:213] op_sel_hi:[1,0]
    v_cvt_pk_bf16_f32 v32, v32, v33
    v_cvt_pk_bf16_f32 v33, v34, v35
    v_cvt_pk_bf16_f32 v34, v36, v37
    v_cvt_pk_bf16_f32 v35, v38, v39
    v_cvt_pk_bf16_f32 v36, v40, v41
    v_cvt_pk_bf16_f32 v37, v42, v43
    v_cvt_pk_bf16_f32 v38, v44, v45
    v_cvt_pk_bf16_f32 v39, v46, v47
    s_waitcnt lgkmcnt(1)
    buffer_store_dwordx4 v[24:27], v254, s[16:19], s52 offen offset:128 sc1
    s_waitcnt lgkmcnt(0)
    buffer_store_dwordx4 v[28:31], v254, s[16:19], s52 offen offset:3200 sc1
    ds_write_b64 v236, v[32:33]
    ds_write_b64 v237, v[34:35]
    ds_write_b64 v238, v[36:37]
    ds_write_b64 v239, v[38:39]
    ds_read_b128 v[40:43], v225
    ds_read2_b64 v[44:47], v225 offset0:129 offset1:130
    v_pk_mul_f32 v[48:49], v[48:49], v[212:213] op_sel:[0,1] op_sel_hi:[1,1]
    v_pk_mul_f32 v[50:51], v[50:51], v[212:213] op_sel:[0,1] op_sel_hi:[1,1]
    v_pk_mul_f32 v[52:53], v[52:53], v[212:213] op_sel:[0,1] op_sel_hi:[1,1]
    v_pk_mul_f32 v[54:55], v[54:55], v[212:213] op_sel:[0,1] op_sel_hi:[1,1]
    v_pk_mul_f32 v[56:57], v[56:57], v[212:213] op_sel:[0,1] op_sel_hi:[1,1]
    v_pk_mul_f32 v[58:59], v[58:59], v[212:213] op_sel:[0,1] op_sel_hi:[1,1]
    v_pk_mul_f32 v[60:61], v[60:61], v[212:213] op_sel:[0,1] op_sel_hi:[1,1]
    v_pk_mul_f32 v[62:63], v[62:63], v[212:213] op_sel:[0,1] op_sel_hi:[1,1]
    v_cvt_pk_bf16_f32 v48, v48, v49
    v_cvt_pk_bf16_f32 v49, v50, v51
    v_cvt_pk_bf16_f32 v50, v52, v53
    v_cvt_pk_bf16_f32 v51, v54, v55
    v_cvt_pk_bf16_f32 v52, v56, v57
    v_cvt_pk_bf16_f32 v53, v58, v59
    v_cvt_pk_bf16_f32 v54, v60, v61
    v_cvt_pk_bf16_f32 v55, v62, v63
    s_waitcnt lgkmcnt(1)
    buffer_store_dwordx4 v[40:43], v254, s[16:19], s52 offen offset:256 sc1
    s_waitcnt lgkmcnt(0)
    buffer_store_dwordx4 v[44:47], v254, s[16:19], s52 offen offset:3328 sc1
    ds_write_b64 v236, v[48:49]
    ds_write_b64 v237, v[50:51]
    ds_write_b64 v238, v[52:53]
    ds_write_b64 v239, v[54:55]
    ds_read_b128 v[56:59], v225
    ds_read2_b64 v[60:63], v225 offset0:129 offset1:130
    v_pk_mul_f32 v[64:65], v[64:65], v[212:213] op_sel:[0,1] op_sel_hi:[1,1]
    v_pk_mul_f32 v[66:67], v[66:67], v[212:213] op_sel:[0,1] op_sel_hi:[1,1]
    v_pk_mul_f32 v[68:69], v[68:69], v[212:213] op_sel:[0,1] op_sel_hi:[1,1]
    v_pk_mul_f32 v[70:71], v[70:71], v[212:213] op_sel:[0,1] op_sel_hi:[1,1]
    v_pk_mul_f32 v[72:73], v[72:73], v[212:213] op_sel:[0,1] op_sel_hi:[1,1]
    v_pk_mul_f32 v[74:75], v[74:75], v[212:213] op_sel:[0,1] op_sel_hi:[1,1]
    v_pk_mul_f32 v[76:77], v[76:77], v[212:213] op_sel:[0,1] op_sel_hi:[1,1]
    v_pk_mul_f32 v[78:79], v[78:79], v[212:213] op_sel:[0,1] op_sel_hi:[1,1]
    v_cvt_pk_bf16_f32 v64, v64, v65
    v_cvt_pk_bf16_f32 v65, v66, v67
    v_cvt_pk_bf16_f32 v66, v68, v69
    v_cvt_pk_bf16_f32 v67, v70, v71
    v_cvt_pk_bf16_f32 v68, v72, v73
    v_cvt_pk_bf16_f32 v69, v74, v75
    v_cvt_pk_bf16_f32 v70, v76, v77
    v_cvt_pk_bf16_f32 v71, v78, v79
    s_waitcnt lgkmcnt(1)
    buffer_store_dwordx4 v[56:59], v254, s[16:19], s53 offen offset:0 sc1
    s_waitcnt lgkmcnt(0)
    buffer_store_dwordx4 v[60:63], v254, s[16:19], s53 offen offset:3072 sc1
    ds_write_b64 v236, v[64:65]
    ds_write_b64 v237, v[66:67]
    ds_write_b64 v238, v[68:69]
    ds_write_b64 v239, v[70:71]
    ds_read_b128 v[72:75], v225
    ds_read2_b64 v[76:79], v225 offset0:129 offset1:130
    v_pk_mul_f32 v[80:81], v[80:81], v[212:213] op_sel:[0,1] op_sel_hi:[1,1]
    v_pk_mul_f32 v[82:83], v[82:83], v[212:213] op_sel:[0,1] op_sel_hi:[1,1]
    v_pk_mul_f32 v[84:85], v[84:85], v[212:213] op_sel:[0,1] op_sel_hi:[1,1]
    v_pk_mul_f32 v[86:87], v[86:87], v[212:213] op_sel:[0,1] op_sel_hi:[1,1]
    v_pk_mul_f32 v[88:89], v[88:89], v[212:213] op_sel:[0,1] op_sel_hi:[1,1]
    v_pk_mul_f32 v[90:91], v[90:91], v[212:213] op_sel:[0,1] op_sel_hi:[1,1]
    v_pk_mul_f32 v[92:93], v[92:93], v[212:213] op_sel:[0,1] op_sel_hi:[1,1]
    v_pk_mul_f32 v[94:95], v[94:95], v[212:213] op_sel:[0,1] op_sel_hi:[1,1]
    v_cvt_pk_bf16_f32 v80, v80, v81
    v_cvt_pk_bf16_f32 v81, v82, v83
    v_cvt_pk_bf16_f32 v82, v84, v85
    v_cvt_pk_bf16_f32 v83, v86, v87
    v_cvt_pk_bf16_f32 v84, v88, v89
    v_cvt_pk_bf16_f32 v85, v90, v91
    v_cvt_pk_bf16_f32 v86, v92, v93
    v_cvt_pk_bf16_f32 v87, v94, v95
    s_waitcnt lgkmcnt(1)
    buffer_store_dwordx4 v[72:75], v254, s[16:19], s53 offen offset:128 sc1
    s_waitcnt lgkmcnt(0)
    buffer_store_dwordx4 v[76:79], v254, s[16:19], s53 offen offset:3200 sc1
    ds_write_b64 v236, v[80:81]
    ds_write_b64 v237, v[82:83]
    ds_write_b64 v238, v[84:85]
    ds_write_b64 v239, v[86:87]
    ds_read_b128 v[88:91], v225
    ds_read2_b64 v[92:95], v225 offset0:129 offset1:130
    v_pk_mul_f32 v[96:97], v[96:97], v[214:215] op_sel_hi:[1,0]
    v_pk_mul_f32 v[98:99], v[98:99], v[214:215] op_sel_hi:[1,0]
    v_pk_mul_f32 v[100:101], v[100:101], v[214:215] op_sel_hi:[1,0]
    v_pk_mul_f32 v[102:103], v[102:103], v[214:215] op_sel_hi:[1,0]
    v_pk_mul_f32 v[104:105], v[104:105], v[214:215] op_sel_hi:[1,0]
    v_pk_mul_f32 v[106:107], v[106:107], v[214:215] op_sel_hi:[1,0]
    v_pk_mul_f32 v[108:109], v[108:109], v[214:215] op_sel_hi:[1,0]
    v_pk_mul_f32 v[110:111], v[110:111], v[214:215] op_sel_hi:[1,0]
    v_cvt_pk_bf16_f32 v96, v96, v97
    v_cvt_pk_bf16_f32 v97, v98, v99
    v_cvt_pk_bf16_f32 v98, v100, v101
    v_cvt_pk_bf16_f32 v99, v102, v103
    v_cvt_pk_bf16_f32 v100, v104, v105
    v_cvt_pk_bf16_f32 v101, v106, v107
    v_cvt_pk_bf16_f32 v102, v108, v109
    v_cvt_pk_bf16_f32 v103, v110, v111
    s_waitcnt lgkmcnt(1)
    buffer_store_dwordx4 v[88:91], v254, s[16:19], s53 offen offset:256 sc1
    s_waitcnt lgkmcnt(0)
    buffer_store_dwordx4 v[92:95], v254, s[16:19], s53 offen offset:3328 sc1
    ds_write_b64 v236, v[96:97]
    ds_write_b64 v237, v[98:99]
    ds_write_b64 v238, v[100:101]
    ds_write_b64 v239, v[102:103]
    ds_read_b128 v[104:107], v225
    ds_read2_b64 v[108:111], v225 offset0:129 offset1:130
    v_pk_mul_f32 v[112:113], v[112:113], v[214:215] op_sel_hi:[1,0]
    v_pk_mul_f32 v[114:115], v[114:115], v[214:215] op_sel_hi:[1,0]
    v_pk_mul_f32 v[116:117], v[116:117], v[214:215] op_sel_hi:[1,0]
    v_pk_mul_f32 v[118:119], v[118:119], v[214:215] op_sel_hi:[1,0]
    v_pk_mul_f32 v[120:121], v[120:121], v[214:215] op_sel_hi:[1,0]
    v_pk_mul_f32 v[122:123], v[122:123], v[214:215] op_sel_hi:[1,0]
    v_pk_mul_f32 v[124:125], v[124:125], v[214:215] op_sel_hi:[1,0]
    v_pk_mul_f32 v[126:127], v[126:127], v[214:215] op_sel_hi:[1,0]
    v_cvt_pk_bf16_f32 v112, v112, v113
    v_cvt_pk_bf16_f32 v113, v114, v115
    v_cvt_pk_bf16_f32 v114, v116, v117
    v_cvt_pk_bf16_f32 v115, v118, v119
    v_cvt_pk_bf16_f32 v116, v120, v121
    v_cvt_pk_bf16_f32 v117, v122, v123
    v_cvt_pk_bf16_f32 v118, v124, v125
    v_cvt_pk_bf16_f32 v119, v126, v127
    s_waitcnt lgkmcnt(1)
    buffer_store_dwordx4 v[104:107], v254, s[16:19], s54 offen offset:0 sc1
    s_waitcnt lgkmcnt(0)
    buffer_store_dwordx4 v[108:111], v254, s[16:19], s54 offen offset:3072 sc1
    ds_write_b64 v236, v[112:113]
    ds_write_b64 v237, v[114:115]
    ds_write_b64 v238, v[116:117]
    ds_write_b64 v239, v[118:119]
    ds_read_b128 v[120:123], v225
    ds_read2_b64 v[124:127], v225 offset0:129 offset1:130
    v_pk_mul_f32 v[128:129], v[128:129], v[214:215] op_sel_hi:[1,0]
    v_pk_mul_f32 v[130:131], v[130:131], v[214:215] op_sel_hi:[1,0]
    v_pk_mul_f32 v[132:133], v[132:133], v[214:215] op_sel_hi:[1,0]
    v_pk_mul_f32 v[134:135], v[134:135], v[214:215] op_sel_hi:[1,0]
    v_pk_mul_f32 v[136:137], v[136:137], v[214:215] op_sel_hi:[1,0]
    v_pk_mul_f32 v[138:139], v[138:139], v[214:215] op_sel_hi:[1,0]
    v_pk_mul_f32 v[140:141], v[140:141], v[214:215] op_sel_hi:[1,0]
    v_pk_mul_f32 v[142:143], v[142:143], v[214:215] op_sel_hi:[1,0]
    v_cvt_pk_bf16_f32 v128, v128, v129
    v_cvt_pk_bf16_f32 v129, v130, v131
    v_cvt_pk_bf16_f32 v130, v132, v133
    v_cvt_pk_bf16_f32 v131, v134, v135
    v_cvt_pk_bf16_f32 v132, v136, v137
    v_cvt_pk_bf16_f32 v133, v138, v139
    v_cvt_pk_bf16_f32 v134, v140, v141
    v_cvt_pk_bf16_f32 v135, v142, v143
    s_waitcnt lgkmcnt(1)
    buffer_store_dwordx4 v[120:123], v254, s[16:19], s54 offen offset:128 sc1
    s_waitcnt lgkmcnt(0)
    buffer_store_dwordx4 v[124:127], v254, s[16:19], s54 offen offset:3200 sc1
    ds_write_b64 v236, v[128:129]
    ds_write_b64 v237, v[130:131]
    ds_write_b64 v238, v[132:133]
    ds_write_b64 v239, v[134:135]
    ds_read_b128 v[136:139], v225
    ds_read2_b64 v[140:143], v225 offset0:129 offset1:130
    v_pk_mul_f32 v[144:145], v[144:145], v[214:215] op_sel:[0,1] op_sel_hi:[1,1]
    v_pk_mul_f32 v[146:147], v[146:147], v[214:215] op_sel:[0,1] op_sel_hi:[1,1]
    v_pk_mul_f32 v[148:149], v[148:149], v[214:215] op_sel:[0,1] op_sel_hi:[1,1]
    v_pk_mul_f32 v[150:151], v[150:151], v[214:215] op_sel:[0,1] op_sel_hi:[1,1]
    v_pk_mul_f32 v[152:153], v[152:153], v[214:215] op_sel:[0,1] op_sel_hi:[1,1]
    v_pk_mul_f32 v[154:155], v[154:155], v[214:215] op_sel:[0,1] op_sel_hi:[1,1]
    v_pk_mul_f32 v[156:157], v[156:157], v[214:215] op_sel:[0,1] op_sel_hi:[1,1]
    v_pk_mul_f32 v[158:159], v[158:159], v[214:215] op_sel:[0,1] op_sel_hi:[1,1]
    v_cvt_pk_bf16_f32 v144, v144, v145
    v_cvt_pk_bf16_f32 v145, v146, v147
    v_cvt_pk_bf16_f32 v146, v148, v149
    v_cvt_pk_bf16_f32 v147, v150, v151
    v_cvt_pk_bf16_f32 v148, v152, v153
    v_cvt_pk_bf16_f32 v149, v154, v155
    v_cvt_pk_bf16_f32 v150, v156, v157
    v_cvt_pk_bf16_f32 v151, v158, v159
    s_waitcnt lgkmcnt(1)
    buffer_store_dwordx4 v[136:139], v254, s[16:19], s54 offen offset:256 sc1
    s_waitcnt lgkmcnt(0)
    buffer_store_dwordx4 v[140:143], v254, s[16:19], s54 offen offset:3328 sc1
    ds_write_b64 v236, v[144:145]
    ds_write_b64 v237, v[146:147]
    ds_write_b64 v238, v[148:149]
    ds_write_b64 v239, v[150:151]
    ds_read_b128 v[152:155], v225
    ds_read2_b64 v[156:159], v225 offset0:129 offset1:130
    v_pk_mul_f32 v[160:161], v[160:161], v[214:215] op_sel:[0,1] op_sel_hi:[1,1]
    v_pk_mul_f32 v[162:163], v[162:163], v[214:215] op_sel:[0,1] op_sel_hi:[1,1]
    v_pk_mul_f32 v[164:165], v[164:165], v[214:215] op_sel:[0,1] op_sel_hi:[1,1]
    v_pk_mul_f32 v[166:167], v[166:167], v[214:215] op_sel:[0,1] op_sel_hi:[1,1]
    v_pk_mul_f32 v[168:169], v[168:169], v[214:215] op_sel:[0,1] op_sel_hi:[1,1]
    v_pk_mul_f32 v[170:171], v[170:171], v[214:215] op_sel:[0,1] op_sel_hi:[1,1]
    v_pk_mul_f32 v[172:173], v[172:173], v[214:215] op_sel:[0,1] op_sel_hi:[1,1]
    v_pk_mul_f32 v[174:175], v[174:175], v[214:215] op_sel:[0,1] op_sel_hi:[1,1]
    v_cvt_pk_bf16_f32 v160, v160, v161
    v_cvt_pk_bf16_f32 v161, v162, v163
    v_cvt_pk_bf16_f32 v162, v164, v165
    v_cvt_pk_bf16_f32 v163, v166, v167
    v_cvt_pk_bf16_f32 v164, v168, v169
    v_cvt_pk_bf16_f32 v165, v170, v171
    v_cvt_pk_bf16_f32 v166, v172, v173
    v_cvt_pk_bf16_f32 v167, v174, v175
    s_add_u32 s52, s35, 18432
    s_waitcnt lgkmcnt(1)
    buffer_store_dwordx4 v[152:155], v254, s[16:19], s52 offen offset:0 sc1
    s_waitcnt lgkmcnt(0)
    buffer_store_dwordx4 v[156:159], v254, s[16:19], s52 offen offset:3072 sc1
    ds_write_b64 v236, v[160:161]
    ds_write_b64 v237, v[162:163]
    ds_write_b64 v238, v[164:165]
    ds_write_b64 v239, v[166:167]
    ds_read_b128 v[168:171], v225
    ds_read2_b64 v[172:175], v225 offset0:129 offset1:130
    v_pk_mul_f32 v[176:177], v[176:177], v[214:215] op_sel:[0,1] op_sel_hi:[1,1]
    v_pk_mul_f32 v[178:179], v[178:179], v[214:215] op_sel:[0,1] op_sel_hi:[1,1]
    v_pk_mul_f32 v[180:181], v[180:181], v[214:215] op_sel:[0,1] op_sel_hi:[1,1]
    v_pk_mul_f32 v[182:183], v[182:183], v[214:215] op_sel:[0,1] op_sel_hi:[1,1]
    v_pk_mul_f32 v[184:185], v[184:185], v[214:215] op_sel:[0,1] op_sel_hi:[1,1]
    v_pk_mul_f32 v[186:187], v[186:187], v[214:215] op_sel:[0,1] op_sel_hi:[1,1]
    v_pk_mul_f32 v[188:189], v[188:189], v[214:215] op_sel:[0,1] op_sel_hi:[1,1]
    v_pk_mul_f32 v[190:191], v[190:191], v[214:215] op_sel:[0,1] op_sel_hi:[1,1]
    v_cvt_pk_bf16_f32 v176, v176, v177
    v_cvt_pk_bf16_f32 v177, v178, v179
    v_cvt_pk_bf16_f32 v178, v180, v181
    v_cvt_pk_bf16_f32 v179, v182, v183
    v_cvt_pk_bf16_f32 v180, v184, v185
    v_cvt_pk_bf16_f32 v181, v186, v187
    v_cvt_pk_bf16_f32 v182, v188, v189
    v_cvt_pk_bf16_f32 v183, v190, v191
    s_waitcnt lgkmcnt(1)
    buffer_store_dwordx4 v[168:171], v254, s[16:19], s52 offen offset:128 sc1
    s_waitcnt lgkmcnt(0)
    buffer_store_dwordx4 v[172:175], v254, s[16:19], s52 offen offset:3200 sc1
    ds_write_b64 v236, v[176:177]
    ds_write_b64 v237, v[178:179]
    ds_write_b64 v238, v[180:181]
    ds_write_b64 v239, v[182:183]
    ds_read_b128 v[184:187], v225
    ds_read2_b64 v[188:191], v225 offset0:129 offset1:130
    v_pk_mul_f32 v[192:193], v[192:193], v[216:217] op_sel_hi:[1,0]
    v_pk_mul_f32 v[194:195], v[194:195], v[216:217] op_sel_hi:[1,0]
    v_pk_mul_f32 v[196:197], v[196:197], v[216:217] op_sel_hi:[1,0]
    v_pk_mul_f32 v[198:199], v[198:199], v[216:217] op_sel_hi:[1,0]
    v_pk_mul_f32 v[200:201], v[200:201], v[216:217] op_sel_hi:[1,0]
    v_pk_mul_f32 v[202:203], v[202:203], v[216:217] op_sel_hi:[1,0]
    v_pk_mul_f32 v[204:205], v[204:205], v[216:217] op_sel_hi:[1,0]
    v_pk_mul_f32 v[206:207], v[206:207], v[216:217] op_sel_hi:[1,0]
    v_cvt_pk_bf16_f32 v192, v192, v193
    v_cvt_pk_bf16_f32 v193, v194, v195
    v_cvt_pk_bf16_f32 v194, v196, v197
    v_cvt_pk_bf16_f32 v195, v198, v199
    v_cvt_pk_bf16_f32 v196, v200, v201
    v_cvt_pk_bf16_f32 v197, v202, v203
    v_cvt_pk_bf16_f32 v198, v204, v205
    v_cvt_pk_bf16_f32 v199, v206, v207
    s_waitcnt lgkmcnt(1)
    buffer_store_dwordx4 v[184:187], v254, s[16:19], s52 offen offset:256 sc1
    s_waitcnt lgkmcnt(0)
    buffer_store_dwordx4 v[188:191], v254, s[16:19], s52 offen offset:3328 sc1
    ds_write_b64 v236, v[192:193]
    ds_write_b64 v237, v[194:195]
    ds_write_b64 v238, v[196:197]
    ds_write_b64 v239, v[198:199]
    ds_read_b128 v[200:203], v225
    ds_read2_b64 v[204:207], v225 offset0:129 offset1:130
    v_mov_b32 v0, v208
    v_mov_b32 v1, v209
    v_mov_b32 v2, v210
    v_mov_b32 v3, v211
    v_accvgpr_read_b32 v4, a180
    v_accvgpr_read_b32 v5, a181
    v_accvgpr_read_b32 v6, a182
    v_accvgpr_read_b32 v7, a183
    v_accvgpr_read_b32 v8, a184
    v_accvgpr_read_b32 v9, a185
    v_accvgpr_read_b32 v10, a186
    v_accvgpr_read_b32 v11, a187
    v_accvgpr_read_b32 v12, a188
    v_accvgpr_read_b32 v13, a189
    v_accvgpr_read_b32 v14, a190
    v_accvgpr_read_b32 v15, a191
    v_pk_mul_f32 v[0:1], v[0:1], v[216:217] op_sel_hi:[1,0]
    v_pk_mul_f32 v[2:3], v[2:3], v[216:217] op_sel_hi:[1,0]
    v_pk_mul_f32 v[4:5], v[4:5], v[216:217] op_sel_hi:[1,0]
    v_pk_mul_f32 v[6:7], v[6:7], v[216:217] op_sel_hi:[1,0]
    v_pk_mul_f32 v[8:9], v[8:9], v[216:217] op_sel_hi:[1,0]
    v_pk_mul_f32 v[10:11], v[10:11], v[216:217] op_sel_hi:[1,0]
    v_pk_mul_f32 v[12:13], v[12:13], v[216:217] op_sel_hi:[1,0]
    v_pk_mul_f32 v[14:15], v[14:15], v[216:217] op_sel_hi:[1,0]
    v_cvt_pk_bf16_f32 v0, v0, v1
    v_cvt_pk_bf16_f32 v1, v2, v3
    v_cvt_pk_bf16_f32 v2, v4, v5
    v_cvt_pk_bf16_f32 v3, v6, v7
    v_cvt_pk_bf16_f32 v4, v8, v9
    v_cvt_pk_bf16_f32 v5, v10, v11
    v_cvt_pk_bf16_f32 v6, v12, v13
    v_cvt_pk_bf16_f32 v7, v14, v15
    s_add_u32 s53, s35, 24576
    s_waitcnt lgkmcnt(1)
    buffer_store_dwordx4 v[200:203], v254, s[16:19], s53 offen offset:0 sc1
    s_waitcnt lgkmcnt(0)
    buffer_store_dwordx4 v[204:207], v254, s[16:19], s53 offen offset:3072 sc1
    ds_write_b64 v236, v[0:1]
    ds_write_b64 v237, v[2:3]
    ds_write_b64 v238, v[4:5]
    ds_write_b64 v239, v[6:7]
    ds_read_b128 v[8:11], v225
    ds_read2_b64 v[12:15], v225 offset0:129 offset1:130
    v_accvgpr_read_b32 v16, a192
    v_accvgpr_read_b32 v17, a193
    v_accvgpr_read_b32 v18, a194
    v_accvgpr_read_b32 v19, a195
    v_accvgpr_read_b32 v20, a196
    v_accvgpr_read_b32 v21, a197
    v_accvgpr_read_b32 v22, a198
    v_accvgpr_read_b32 v23, a199
    v_accvgpr_read_b32 v24, a200
    v_accvgpr_read_b32 v25, a201
    v_accvgpr_read_b32 v26, a202
    v_accvgpr_read_b32 v27, a203
    v_accvgpr_read_b32 v28, a204
    v_accvgpr_read_b32 v29, a205
    v_accvgpr_read_b32 v30, a206
    v_accvgpr_read_b32 v31, a207
    v_pk_mul_f32 v[16:17], v[16:17], v[216:217] op_sel_hi:[1,0]
    v_pk_mul_f32 v[18:19], v[18:19], v[216:217] op_sel_hi:[1,0]
    v_pk_mul_f32 v[20:21], v[20:21], v[216:217] op_sel_hi:[1,0]
    v_pk_mul_f32 v[22:23], v[22:23], v[216:217] op_sel_hi:[1,0]
    v_pk_mul_f32 v[24:25], v[24:25], v[216:217] op_sel_hi:[1,0]
    v_pk_mul_f32 v[26:27], v[26:27], v[216:217] op_sel_hi:[1,0]
    v_pk_mul_f32 v[28:29], v[28:29], v[216:217] op_sel_hi:[1,0]
    v_pk_mul_f32 v[30:31], v[30:31], v[216:217] op_sel_hi:[1,0]
    v_cvt_pk_bf16_f32 v16, v16, v17
    v_cvt_pk_bf16_f32 v17, v18, v19
    v_cvt_pk_bf16_f32 v18, v20, v21
    v_cvt_pk_bf16_f32 v19, v22, v23
    v_cvt_pk_bf16_f32 v20, v24, v25
    v_cvt_pk_bf16_f32 v21, v26, v27
    v_cvt_pk_bf16_f32 v22, v28, v29
    v_cvt_pk_bf16_f32 v23, v30, v31
    s_waitcnt lgkmcnt(1)
    buffer_store_dwordx4 v[8:11], v254, s[16:19], s53 offen offset:128 sc1
    s_waitcnt lgkmcnt(0)
    buffer_store_dwordx4 v[12:15], v254, s[16:19], s53 offen offset:3200 sc1
    ds_write_b64 v236, v[16:17]
    ds_write_b64 v237, v[18:19]
    ds_write_b64 v238, v[20:21]
    ds_write_b64 v239, v[22:23]
    ds_read_b128 v[24:27], v225
    ds_read2_b64 v[28:31], v225 offset0:129 offset1:130
    v_accvgpr_read_b32 v32, a208
    v_accvgpr_read_b32 v33, a209
    v_accvgpr_read_b32 v34, a210
    v_accvgpr_read_b32 v35, a211
    v_accvgpr_read_b32 v36, a212
    v_accvgpr_read_b32 v37, a213
    v_accvgpr_read_b32 v38, a214
    v_accvgpr_read_b32 v39, a215
    v_accvgpr_read_b32 v40, a216
    v_accvgpr_read_b32 v41, a217
    v_accvgpr_read_b32 v42, a218
    v_accvgpr_read_b32 v43, a219
    v_accvgpr_read_b32 v44, a220
    v_accvgpr_read_b32 v45, a221
    v_accvgpr_read_b32 v46, a222
    v_accvgpr_read_b32 v47, a223
    v_pk_mul_f32 v[32:33], v[32:33], v[216:217] op_sel:[0,1] op_sel_hi:[1,1]
    v_pk_mul_f32 v[34:35], v[34:35], v[216:217] op_sel:[0,1] op_sel_hi:[1,1]
    v_pk_mul_f32 v[36:37], v[36:37], v[216:217] op_sel:[0,1] op_sel_hi:[1,1]
    v_pk_mul_f32 v[38:39], v[38:39], v[216:217] op_sel:[0,1] op_sel_hi:[1,1]
    v_pk_mul_f32 v[40:41], v[40:41], v[216:217] op_sel:[0,1] op_sel_hi:[1,1]
    v_pk_mul_f32 v[42:43], v[42:43], v[216:217] op_sel:[0,1] op_sel_hi:[1,1]
    v_pk_mul_f32 v[44:45], v[44:45], v[216:217] op_sel:[0,1] op_sel_hi:[1,1]
    v_pk_mul_f32 v[46:47], v[46:47], v[216:217] op_sel:[0,1] op_sel_hi:[1,1]
    v_cvt_pk_bf16_f32 v32, v32, v33
    v_cvt_pk_bf16_f32 v33, v34, v35
    v_cvt_pk_bf16_f32 v34, v36, v37
    v_cvt_pk_bf16_f32 v35, v38, v39
    v_cvt_pk_bf16_f32 v36, v40, v41
    v_cvt_pk_bf16_f32 v37, v42, v43
    v_cvt_pk_bf16_f32 v38, v44, v45
    v_cvt_pk_bf16_f32 v39, v46, v47
    s_waitcnt lgkmcnt(1)
    buffer_store_dwordx4 v[24:27], v254, s[16:19], s53 offen offset:256 sc1
    s_waitcnt lgkmcnt(0)
    buffer_store_dwordx4 v[28:31], v254, s[16:19], s53 offen offset:3328 sc1
    ds_write_b64 v236, v[32:33]
    ds_write_b64 v237, v[34:35]
    ds_write_b64 v238, v[36:37]
    ds_write_b64 v239, v[38:39]
    ds_read_b128 v[40:43], v225
    ds_read2_b64 v[44:47], v225 offset0:129 offset1:130
    v_accvgpr_read_b32 v48, a224
    v_accvgpr_read_b32 v49, a225
    v_accvgpr_read_b32 v50, a226
    v_accvgpr_read_b32 v51, a227
    v_accvgpr_read_b32 v52, a228
    v_accvgpr_read_b32 v53, a229
    v_accvgpr_read_b32 v54, a230
    v_accvgpr_read_b32 v55, a231
    v_accvgpr_read_b32 v56, a232
    v_accvgpr_read_b32 v57, a233
    v_accvgpr_read_b32 v58, a234
    v_accvgpr_read_b32 v59, a235
    v_accvgpr_read_b32 v60, a236
    v_accvgpr_read_b32 v61, a237
    v_accvgpr_read_b32 v62, a238
    v_accvgpr_read_b32 v63, a239
    v_pk_mul_f32 v[48:49], v[48:49], v[216:217] op_sel:[0,1] op_sel_hi:[1,1]
    v_pk_mul_f32 v[50:51], v[50:51], v[216:217] op_sel:[0,1] op_sel_hi:[1,1]
    v_pk_mul_f32 v[52:53], v[52:53], v[216:217] op_sel:[0,1] op_sel_hi:[1,1]
    v_pk_mul_f32 v[54:55], v[54:55], v[216:217] op_sel:[0,1] op_sel_hi:[1,1]
    v_pk_mul_f32 v[56:57], v[56:57], v[216:217] op_sel:[0,1] op_sel_hi:[1,1]
    v_pk_mul_f32 v[58:59], v[58:59], v[216:217] op_sel:[0,1] op_sel_hi:[1,1]
    v_pk_mul_f32 v[60:61], v[60:61], v[216:217] op_sel:[0,1] op_sel_hi:[1,1]
    v_pk_mul_f32 v[62:63], v[62:63], v[216:217] op_sel:[0,1] op_sel_hi:[1,1]
    v_cvt_pk_bf16_f32 v48, v48, v49
    v_cvt_pk_bf16_f32 v49, v50, v51
    v_cvt_pk_bf16_f32 v50, v52, v53
    v_cvt_pk_bf16_f32 v51, v54, v55
    v_cvt_pk_bf16_f32 v52, v56, v57
    v_cvt_pk_bf16_f32 v53, v58, v59
    v_cvt_pk_bf16_f32 v54, v60, v61
    v_cvt_pk_bf16_f32 v55, v62, v63
    s_add_u32 s54, s35, 30720
    s_waitcnt lgkmcnt(1)
    buffer_store_dwordx4 v[40:43], v254, s[16:19], s54 offen offset:0 sc1
    s_waitcnt lgkmcnt(0)
    buffer_store_dwordx4 v[44:47], v254, s[16:19], s54 offen offset:3072 sc1
    ds_write_b64 v236, v[48:49]
    ds_write_b64 v237, v[50:51]
    ds_write_b64 v238, v[52:53]
    ds_write_b64 v239, v[54:55]
    ds_read_b128 v[56:59], v225
    ds_read2_b64 v[60:63], v225 offset0:129 offset1:130
    v_accvgpr_read_b32 v64, a240
    v_accvgpr_read_b32 v65, a241
    v_accvgpr_read_b32 v66, a242
    v_accvgpr_read_b32 v67, a243
    v_accvgpr_read_b32 v68, a244
    v_accvgpr_read_b32 v69, a245
    v_accvgpr_read_b32 v70, a246
    v_accvgpr_read_b32 v71, a247
    v_accvgpr_read_b32 v72, a248
    v_accvgpr_read_b32 v73, a249
    v_accvgpr_read_b32 v74, a250
    v_accvgpr_read_b32 v75, a251
    v_accvgpr_read_b32 v76, a252
    v_accvgpr_read_b32 v77, a253
    v_accvgpr_read_b32 v78, a254
    v_accvgpr_read_b32 v79, a255
    v_pk_mul_f32 v[64:65], v[64:65], v[216:217] op_sel:[0,1] op_sel_hi:[1,1]
    v_pk_mul_f32 v[66:67], v[66:67], v[216:217] op_sel:[0,1] op_sel_hi:[1,1]
    v_pk_mul_f32 v[68:69], v[68:69], v[216:217] op_sel:[0,1] op_sel_hi:[1,1]
    v_pk_mul_f32 v[70:71], v[70:71], v[216:217] op_sel:[0,1] op_sel_hi:[1,1]
    v_pk_mul_f32 v[72:73], v[72:73], v[216:217] op_sel:[0,1] op_sel_hi:[1,1]
    v_pk_mul_f32 v[74:75], v[74:75], v[216:217] op_sel:[0,1] op_sel_hi:[1,1]
    v_pk_mul_f32 v[76:77], v[76:77], v[216:217] op_sel:[0,1] op_sel_hi:[1,1]
    v_pk_mul_f32 v[78:79], v[78:79], v[216:217] op_sel:[0,1] op_sel_hi:[1,1]
    v_cvt_pk_bf16_f32 v64, v64, v65
    v_cvt_pk_bf16_f32 v65, v66, v67
    v_cvt_pk_bf16_f32 v66, v68, v69
    v_cvt_pk_bf16_f32 v67, v70, v71
    v_cvt_pk_bf16_f32 v68, v72, v73
    v_cvt_pk_bf16_f32 v69, v74, v75
    v_cvt_pk_bf16_f32 v70, v76, v77
    v_cvt_pk_bf16_f32 v71, v78, v79
    s_waitcnt lgkmcnt(1)
    buffer_store_dwordx4 v[56:59], v254, s[16:19], s54 offen offset:128 sc1
    s_waitcnt lgkmcnt(0)
    buffer_store_dwordx4 v[60:63], v254, s[16:19], s54 offen offset:3200 sc1
    ds_write_b64 v236, v[64:65]
    ds_write_b64 v237, v[66:67]
    ds_write_b64 v238, v[68:69]
    ds_write_b64 v239, v[70:71]
    ds_read_b128 v[72:75], v225
    ds_read2_b64 v[76:79], v225 offset0:129 offset1:130
    s_waitcnt lgkmcnt(1)
    buffer_store_dwordx4 v[72:75], v254, s[16:19], s54 offen offset:256 sc1
    s_waitcnt lgkmcnt(0)
    buffer_store_dwordx4 v[76:79], v254, s[16:19], s54 offen offset:3328 sc1
    s_cmp_eq_u32 s34, 0
    s_cbranch_scc1 L_end
    s_waitcnt vmcnt(0) lgkmcnt(0)
    v_mbcnt_lo_u32_b32 v137, -1, 0
    v_mbcnt_hi_u32_b32 v137, -1, v137
    v_and_b32 v134, 15, v137
    v_mul_u32_u24 v134, 384, v134
    v_lshrrev_b32 v135, 4, v137
    v_lshl_add_u32 v142, v135, 4, v134
    v_bfe_u32 v134, v137, 2, 3
    v_and_b32 v135, 6, v134
    v_lshlrev_b32 v135, 4, v135
    v_lshl_add_u32 v134, v134, 7, v135
    v_and_b32 v135, 3, v137
    v_lshl_add_u32 v134, v135, 3, v134
    v_lshrrev_b32 v135, 5, v137
    v_mul_u32_u24 v135, 3072, v135
    v_add_u32 v138, v134, v135
    v_add_u32 v138, s36, v138
    v_xor_b32 v139, 32, v138
    v_xor_b32 v140, 64, v138
    v_xor_b32 v141, 96, v138
    s_mov_b32 s46, 0
L_sl_head:
    s_lshr_b32 s42, s34, s46
    s_and_b32 s42, s42, 1
    s_cbranch_scc0 L_sl_next
    s_mov_b32 s47, 0
L_sl_q:
    s_mul_i32 s49, s46, 147456
    s_mul_i32 s42, s3, 36864
    s_add_u32 s49, s49, s42
    s_mul_i32 s42, s47, 6144
    s_add_u32 s49, s49, s42
    buffer_load_dwordx4 v[0:3], v142, s[4:7], s49 offen offset:0
    buffer_load_dwordx4 v[4:7], v142, s[4:7], s49 offen offset:64
    buffer_load_dwordx4 v[8:11], v142, s[4:7], s49 offen offset:128
    buffer_load_dwordx4 v[12:15], v142, s[4:7], s49 offen offset:192
    buffer_load_dwordx4 v[16:19], v142, s[4:7], s49 offen offset:256
    buffer_load_dwordx4 v[20:23], v142, s[4:7], s49 offen offset:320
    v_mov_b32 v72, 0
    v_mov_b32 v73, 0
    v_mov_b32 v74, 0
    v_mov_b32 v75, 0
    v_mov_b32 v76, 0
    v_mov_b32 v77, 0
    v_mov_b32 v78, 0
    v_mov_b32 v79, 0
    v_mov_b32 v80, 0
    v_mov_b32 v81, 0
    v_mov_b32 v82, 0
    v_mov_b32 v83, 0
    v_mov_b32 v84, 0
    v_mov_b32 v85, 0
    v_mov_b32 v86, 0
    v_mov_b32 v87, 0
    v_mov_b32 v88, 0
    v_mov_b32 v89, 0
    v_mov_b32 v90, 0
    v_mov_b32 v91, 0
    v_mov_b32 v92, 0
    v_mov_b32 v93, 0
    v_mov_b32 v94, 0
    v_mov_b32 v95, 0
    v_mov_b32 v96, 0
    v_mov_b32 v97, 0
    v_mov_b32 v98, 0
    v_mov_b32 v99, 0
    v_mov_b32 v100, 0
    v_mov_b32 v101, 0
    v_mov_b32 v102, 0
    v_mov_b32 v103, 0
    v_mov_b32 v104, 0
    v_mov_b32 v105, 0
    v_mov_b32 v106, 0
    v_mov_b32 v107, 0
    v_mov_b32 v108, 0
    v_mov_b32 v109, 0
    v_mov_b32 v110, 0
    v_mov_b32 v111, 0
    v_mov_b32 v112, 0
    v_mov_b32 v113, 0
    v_mov_b32 v114, 0
    v_mov_b32 v115, 0
    v_mov_b32 v116, 0
    v_mov_b32 v117, 0
    v_mov_b32 v118, 0
    v_mov_b32 v119, 0
    v_mov_b32 v132, 0xff800000
    v_mov_b32 v133, 0
    s_mul_i32 s50, s46, 196608
    s_mov_b32 s48, 16
L_sl_t:
    s_add_u32 s42, s50, 0
    buffer_load_dwordx4 v[24:27], v142, s[8:11], s42 offen offset:0
    buffer_load_dwordx4 v[28:31], v142, s[8:11], s42 offen offset:64
    buffer_load_dwordx4 v[32:35], v142, s[8:11], s42 offen offset:128
    buffer_load_dwordx4 v[36:39], v142, s[8:11], s42 offen offset:192
    buffer_load_dwordx4 v[40:43], v142, s[8:11], s42 offen offset:256
    buffer_load_dwordx4 v[44:47], v142, s[8:11], s42 offen offset:320
    s_add_u32 s42, s50, 6144
    buffer_load_dwordx4 v[48:51], v142, s[8:11], s42 offen offset:0
    buffer_load_dwordx4 v[52:55], v142, s[8:11], s42 offen offset:64
    buffer_load_dwordx4 v[56:59], v142, s[8:11], s42 offen offset:128
    buffer_load_dwordx4 v[60:63], v142, s[8:11], s42 offen offset:192
    buffer_load_dwordx4 v[64:67], v142, s[8:11], s42 offen offset:256
    buffer_load_dwordx4 v[68:71], v142, s[8:11], s42 offen offset:320
    s_add_u32 s42, s50, 0
    s_add_u32 m0, s36, 0
    s_nop 0
    buffer_load_dwordx4 v254, s[12:15], s42 offen offset:0 lds
    s_add_u32 m0, s36, 896
    s_nop 0
    buffer_load_dwordx4 v254, s[12:15], s42 offen offset:128 lds
    s_add_u32 m0, s36, 1792
    s_nop 0
    buffer_load_dwordx4 v254, s[12:15], s42 offen offset:256 lds
    s_add_u32 s42, s50, 3072
    s_add_u32 m0, s36, 3072
    s_nop 0
    buffer_load_dwordx4 v254, s[12:15], s42 offen offset:0 lds
    s_add_u32 m0, s36, 3968
    s_nop 0
    buffer_load_dwordx4 v254, s[12:15], s42 offen offset:128 lds
    s_add_u32 m0, s36, 4864
    s_nop 0
    buffer_load_dwordx4 v254, s[12:15], s42 offen offset:256 lds
    s_add_u32 s42, s50, 6144
    s_add_u32 m0, s36, 6144
    s_nop 0
    buffer_load_dwordx4 v254, s[12:15], s42 offen offset:0 lds
    s_add_u32 m0, s36, 7040
    s_nop 0
    buffer_load_dwordx4 v254, s[12:15], s42 offen offset:128 lds
    s_add_u32 m0, s36, 7936
    s_nop 0
    buffer_load_dwordx4 v254, s[12:15], s42 offen offset:256 lds
    s_add_u32 s42, s50, 9216
    s_add_u32 m0, s36, 9216
    s_nop 0
    buffer_load_dwordx4 v254, s[12:15], s42 offen offset:0 lds
    s_add_u32 m0, s36, 10112
    s_nop 0
    buffer_load_dwordx4 v254, s[12:15], s42 offen offset:128 lds
    s_add_u32 m0, s36, 11008
    s_nop 0
    buffer_load_dwordx4 v254, s[12:15], s42 offen offset:256 lds
    s_waitcnt vmcnt(0)
    v_mfma_f32_16x16x32_bf16 v[120:123], v[24:27], v[0:3], 0
    v_mfma_f32_16x16x32_bf16 v[120:123], v[28:31], v[4:7], v[120:123]
    v_mfma_f32_16x16x32_bf16 v[120:123], v[32:35], v[8:11], v[120:123]
    v_mfma_f32_16x16x32_bf16 v[120:123], v[36:39], v[12:15], v[120:123]
    v_mfma_f32_16x16x32_bf16 v[120:123], v[40:43], v[16:19], v[120:123]
    v_mfma_f32_16x16x32_bf16 v[120:123], v[44:47], v[20:23], v[120:123]
    v_mfma_f32_16x16x32_bf16 v[124:127], v[48:51], v[0:3], 0
    v_mfma_f32_16x16x32_bf16 v[124:127], v[52:55], v[4:7], v[124:127]
    v_mfma_f32_16x16x32_bf16 v[124:127], v[56:59], v[8:11], v[124:127]
    v_mfma_f32_16x16x32_bf16 v[124:127], v[60:63], v[12:15], v[124:127]
    v_mfma_f32_16x16x32_bf16 v[124:127], v[64:67], v[16:19], v[124:127]
    v_mfma_f32_16x16x32_bf16 v[124:127], v[68:71], v[20:23], v[124:127]
    ds_read_b64_tr_b16 v[24:25], v138 offset:0
    ds_read_b64_tr_b16 v[26:27], v138 offset:6144
    ds_read_b64_tr_b16 v[28:29], v139 offset:0
    ds_read_b64_tr_b16 v[30:31], v139 offset:6144
    ds_read_b64_tr_b16 v[32:33], v140 offset:0
    ds_read_b64_tr_b16 v[34:35], v140 offset:6144
    ds_read_b64_tr_b16 v[36:37], v141 offset:0
    ds_read_b64_tr_b16 v[38:39], v141 offset:6144
    ds_read_b64_tr_b16 v[40:41], v138 offset:1024
    ds_read_b64_tr_b16 v[42:43], v138 offset:7168
    ds_read_b64_tr_b16 v[44:45], v139 offset:1024
    ds_read_b64_tr_b16 v[46:47], v139 offset:7168
    ds_read_b64_tr_b16 v[48:49], v140 offset:1024
    ds_read_b64_tr_b16 v[50:51], v140 offset:7168
    ds_read_b64_tr_b16 v[52:53], v141 offset:1024
    ds_read_b64_tr_b16 v[54:55], v141 offset:7168
    ds_read_b64_tr_b16 v[56:57], v138 offset:2048
    ds_read_b64_tr_b16 v[58:59], v138 offset:8192
    ds_read_b64_tr_b16 v[60:61], v139 offset:2048
    ds_read_b64_tr_b16 v[62:63], v139 offset:8192
    ds_read_b64_tr_b16 v[64:65], v140 offset:2048
    ds_read_b64_tr_b16 v[66:67], v140 offset:8192
    ds_read_b64_tr_b16 v[68:69], v141 offset:2048
    ds_read_b64_tr_b16 v[70:71], v141 offset:8192
    v_max3_f32 v134, v120, v121, v122
    v_max3_f32 v134, v134, v123, v124
    v_max3_f32 v134, v134, v125, v126
    v_max3_f32 v134, v134, v127, v132
    v_mov_b32 v135, v134
    s_nop 1
    v_permlane32_swap_b32 v135, v134
    v_max_f32 v134, v135, v134
    v_mov_b32 v135, v134
    s_nop 1
    v_permlane16_swap_b32 v135, v134
    v_max_f32 v134, v135, v134
    v_sub_f32 v136, v132, v134
    v_mul_f32 v136, s24, v136
    v_exp_f32 v136, v136
    v_mov_b32 v132, v134
    v_sub_f32 v120, v120, v132
    v_sub_f32 v121, v121, v132
    v_sub_f32 v122, v122, v132
    v_sub_f32 v123, v123, v132
    v_sub_f32 v124, v124, v132
    v_sub_f32 v125, v125, v132
    v_sub_f32 v126, v126, v132
    v_sub_f32 v127, v127, v132
    v_mul_f32 v120, s24, v120
    v_mul_f32 v121, s24, v121
    v_mul_f32 v122, s24, v122
    v_mul_f32 v123, s24, v123
    v_mul_f32 v124, s24, v124
    v_mul_f32 v125, s24, v125
    v_mul_f32 v126, s24, v126
    v_mul_f32 v127, s24, v127
    v_exp_f32 v120, v120
    v_exp_f32 v121, v121
    v_exp_f32 v122, v122
    v_exp_f32 v123, v123
    v_exp_f32 v124, v124
    v_exp_f32 v125, v125
    v_exp_f32 v126, v126
    v_exp_f32 v127, v127
    v_mul_f32 v133, v133, v136
    v_add_f32 v133, v133, v120
    v_add_f32 v133, v133, v121
    v_add_f32 v133, v133, v122
    v_add_f32 v133, v133, v123
    v_add_f32 v133, v133, v124
    v_add_f32 v133, v133, v125
    v_add_f32 v133, v133, v126
    v_add_f32 v133, v133, v127
    v_cvt_pk_bf16_f32 v128, v120, v121
    v_cvt_pk_bf16_f32 v129, v122, v123
    v_cvt_pk_bf16_f32 v130, v124, v125
    v_cvt_pk_bf16_f32 v131, v126, v127
    v_mul_f32 v72, v72, v136
    v_mul_f32 v73, v73, v136
    v_mul_f32 v74, v74, v136
    v_mul_f32 v75, v75, v136
    v_mul_f32 v76, v76, v136
    v_mul_f32 v77, v77, v136
    v_mul_f32 v78, v78, v136
    v_mul_f32 v79, v79, v136
    v_mul_f32 v80, v80, v136
    v_mul_f32 v81, v81, v136
    v_mul_f32 v82, v82, v136
    v_mul_f32 v83, v83, v136
    v_mul_f32 v84, v84, v136
    v_mul_f32 v85, v85, v136
    v_mul_f32 v86, v86, v136
    v_mul_f32 v87, v87, v136
    v_mul_f32 v88, v88, v136
    v_mul_f32 v89, v89, v136
    v_mul_f32 v90, v90, v136
    v_mul_f32 v91, v91, v136
    v_mul_f32 v92, v92, v136
    v_mul_f32 v93, v93, v136
    v_mul_f32 v94, v94, v136
    v_mul_f32 v95, v95, v136
    v_mul_f32 v96, v96, v136
    v_mul_f32 v97, v97, v136
    v_mul_f32 v98, v98, v136
    v_mul_f32 v99, v99, v136
    v_mul_f32 v100, v100, v136
    v_mul_f32 v101, v101, v136
    v_mul_f32 v102, v102, v136
    v_mul_f32 v103, v103, v136
    v_mul_f32 v104, v104, v136
    v_mul_f32 v105, v105, v136
    v_mul_f32 v106, v106, v136
    v_mul_f32 v107, v107, v136
    v_mul_f32 v108, v108, v136
    v_mul_f32 v109, v109, v136
    v_mul_f32 v110, v110, v136
    v_mul_f32 v111, v111, v136
    v_mul_f32 v112, v112, v136
    v_mul_f32 v113, v113, v136
    v_mul_f32 v114, v114, v136
    v_mul_f32 v115, v115, v136
    v_mul_f32 v116, v116, v136
    v_mul_f32 v117, v117, v136
    v_mul_f32 v118, v118, v136
    v_mul_f32 v119, v119, v136
    s_waitcnt lgkmcnt(0)
    s_nop 1
    v_mfma_f32_16x16x32_bf16 v[72:75], v[24:27], v[128:131], v[72:75]
    v_mfma_f32_16x16x32_bf16 v[76:79], v[28:31], v[128:131], v[76:79]
    v_mfma_f32_16x16x32_bf16 v[80:83], v[32:35], v[128:131], v[80:83]
    v_mfma_f32_16x16x32_bf16 v[84:87], v[36:39], v[128:131], v[84:87]
    v_mfma_f32_16x16x32_bf16 v[88:91], v[40:43], v[128:131], v[88:91]
    v_mfma_f32_16x16x32_bf16 v[92:95], v[44:47], v[128:131], v[92:95]
    v_mfma_f32_16x16x32_bf16 v[96:99], v[48:51], v[128:131], v[96:99]
    v_mfma_f32_16x16x32_bf16 v[100:103], v[52:55], v[128:131], v[100:103]
    v_mfma_f32_16x16x32_bf16 v[104:107], v[56:59], v[128:131], v[104:107]
    v_mfma_f32_16x16x32_bf16 v[108:111], v[60:63], v[128:131], v[108:111]
    v_mfma_f32_16x16x32_bf16 v[112:115], v[64:67], v[128:131], v[112:115]
    v_mfma_f32_16x16x32_bf16 v[116:119], v[68:71], v[128:131], v[116:119]
    s_nop 15
    s_add_u32 s50, s50, 12288
    s_sub_u32 s48, s48, 1
    s_cmp_lg_u32 s48, 0
    s_cbranch_scc1 L_sl_t
    v_mov_b32 v135, v133
    s_nop 1
    v_permlane32_swap_b32 v135, v133
    v_add_f32 v133, v135, v133
    v_mov_b32 v135, v133
    s_nop 1
    v_permlane16_swap_b32 v135, v133
    v_add_f32 v133, v135, v133
    v_rcp_f32 v133, v133
    v_lshrrev_b32 v134, 4, v137
    v_lshlrev_b32 v134, 3, v134
    v_sub_u32 v134, v142, v134
    v_mul_f32 v72, v72, v133
    v_mul_f32 v73, v73, v133
    v_mul_f32 v74, v74, v133
    v_mul_f32 v75, v75, v133
    v_mul_f32 v76, v76, v133
    v_mul_f32 v77, v77, v133
    v_mul_f32 v78, v78, v133
    v_mul_f32 v79, v79, v133
    v_mul_f32 v80, v80, v133
    v_mul_f32 v81, v81, v133
    v_mul_f32 v82, v82, v133
    v_mul_f32 v83, v83, v133
    v_mul_f32 v84, v84, v133
    v_mul_f32 v85, v85, v133
    v_mul_f32 v86, v86, v133
    v_mul_f32 v87, v87, v133
    v_mul_f32 v88, v88, v133
    v_mul_f32 v89, v89, v133
    v_mul_f32 v90, v90, v133
    v_mul_f32 v91, v91, v133
    v_mul_f32 v92, v92, v133
    v_mul_f32 v93, v93, v133
    v_mul_f32 v94, v94, v133
    v_mul_f32 v95, v95, v133
    v_mul_f32 v96, v96, v133
    v_mul_f32 v97, v97, v133
    v_mul_f32 v98, v98, v133
    v_mul_f32 v99, v99, v133
    v_mul_f32 v100, v100, v133
    v_mul_f32 v101, v101, v133
    v_mul_f32 v102, v102, v133
    v_mul_f32 v103, v103, v133
    v_mul_f32 v104, v104, v133
    v_mul_f32 v105, v105, v133
    v_mul_f32 v106, v106, v133
    v_mul_f32 v107, v107, v133
    v_mul_f32 v108, v108, v133
    v_mul_f32 v109, v109, v133
    v_mul_f32 v110, v110, v133
    v_mul_f32 v111, v111, v133
    v_mul_f32 v112, v112, v133
    v_mul_f32 v113, v113, v133
    v_mul_f32 v114, v114, v133
    v_mul_f32 v115, v115, v133
    v_mul_f32 v116, v116, v133
    v_mul_f32 v117, v117, v133
    v_mul_f32 v118, v118, v133
    v_mul_f32 v119, v119, v133
    v_cvt_pk_bf16_f32 v24, v72, v73
    v_cvt_pk_bf16_f32 v25, v74, v75
    v_cvt_pk_bf16_f32 v26, v76, v77
    v_cvt_pk_bf16_f32 v27, v78, v79
    v_cvt_pk_bf16_f32 v28, v80, v81
    v_cvt_pk_bf16_f32 v29, v82, v83
    v_cvt_pk_bf16_f32 v30, v84, v85
    v_cvt_pk_bf16_f32 v31, v86, v87
    v_cvt_pk_bf16_f32 v32, v88, v89
    v_cvt_pk_bf16_f32 v33, v90, v91
    v_cvt_pk_bf16_f32 v34, v92, v93
    v_cvt_pk_bf16_f32 v35, v94, v95
    v_cvt_pk_bf16_f32 v36, v96, v97
    v_cvt_pk_bf16_f32 v37, v98, v99
    v_cvt_pk_bf16_f32 v38, v100, v101
    v_cvt_pk_bf16_f32 v39, v102, v103
    v_cvt_pk_bf16_f32 v40, v104, v105
    v_cvt_pk_bf16_f32 v41, v106, v107
    v_cvt_pk_bf16_f32 v42, v108, v109
    v_cvt_pk_bf16_f32 v43, v110, v111
    v_cvt_pk_bf16_f32 v44, v112, v113
    v_cvt_pk_bf16_f32 v45, v114, v115
    v_cvt_pk_bf16_f32 v46, v116, v117
    v_cvt_pk_bf16_f32 v47, v118, v119
    buffer_store_dwordx2 v[24:25], v134, s[16:19], s49 offen offset:0
    buffer_store_dwordx2 v[26:27], v134, s[16:19], s49 offen offset:32
    buffer_store_dwordx2 v[28:29], v134, s[16:19], s49 offen offset:64
    buffer_store_dwordx2 v[30:31], v134, s[16:19], s49 offen offset:96
    buffer_store_dwordx2 v[32:33], v134, s[16:19], s49 offen offset:128
    buffer_store_dwordx2 v[34:35], v134, s[16:19], s49 offen offset:160
    buffer_store_dwordx2 v[36:37], v134, s[16:19], s49 offen offset:192
    buffer_store_dwordx2 v[38:39], v134, s[16:19], s49 offen offset:224
    buffer_store_dwordx2 v[40:41], v134, s[16:19], s49 offen offset:256
    buffer_store_dwordx2 v[42:43], v134, s[16:19], s49 offen offset:288
    buffer_store_dwordx2 v[44:45], v134, s[16:19], s49 offen offset:320
    buffer_store_dwordx2 v[46:47], v134, s[16:19], s49 offen offset:352
    s_waitcnt vmcnt(0)
    s_add_u32 s47, s47, 1
    s_cmp_lt_u32 s47, 6
    s_cbranch_scc1 L_sl_q
L_sl_next:
    s_add_u32 s46, s46, 1
    s_cmp_lt_u32 s46, 2
    s_cbranch_scc1 L_sl_head
L_end:
    s_endpgm
.section .rodata,"a"
.p2align 6
.amdhsa_kernel standalone__mha_softmax__near_ridge_kernel
  .amdhsa_next_free_vgpr 512
  .amdhsa_next_free_sgpr 96
  .amdhsa_accum_offset 256
  .amdhsa_group_segment_fixed_size 0
  .amdhsa_kernarg_size 48
  .amdhsa_user_sgpr_count 2
  .amdhsa_user_sgpr_kernarg_segment_ptr 1
  .amdhsa_system_sgpr_workgroup_id_x 1
.end_amdhsa_kernel
```
